```python
import torch

def _softmax(x, axis=-1):
    return torch.softmax(x, dim=axis)
def _gelu(x):
    return torch.nn.functional.gelu(x, approximate="tanh")
def _silu(x):
    return torch.nn.functional.silu(x)
def _sigmoid(x):
    return torch.sigmoid(x)
def _layernorm(x, axis=-1, eps=1e-5):
    m = x.mean(dim=axis, keepdim=True)
    v = x.var(dim=axis, keepdim=True, unbiased=False)
    return (x - m) / torch.sqrt(v + eps)
def _scatter_add(tgt, idx, src, axis=0):
    return tgt.clone().index_add_(axis, idx, src)
def _segment_sum(src, seg, n):
    out = torch.zeros((n,) + src.shape[1:], dtype=src.dtype)
    return out.index_add_(0, seg, src)
def _pad(x, pw):
    flat = tuple(v for pair in reversed(pw) for v in pair)
    return torch.nn.functional.pad(x, flat)

kernel_name = 'gated_mix__sliding_block__dense_activation_relu__prompt'

def setup_inputs():

    _w = (lambda a: (lambda t: t.to(torch.bfloat16) if t.is_floating_point() else t)(torch.as_tensor(a)))
    def _A_setup():
        B, S, D = 1, 2048, 512
        return {
            "x": _w((lambda *s: torch.randn(*s, dtype=torch.bfloat16) * 0.05)(B, S, D)),
            "wqkv": _w((lambda *s: torch.randn(*s, dtype=torch.bfloat16) * 0.8)(D, 3 * D)),
            "wo": _w((lambda *s: torch.randn(*s, dtype=torch.bfloat16) * 0.05)(D, D)),
        }
    _A_in = _A_setup()

    def _B_setup():
        B, S, D, Dff = 1, 2048, 512, 1376
        return {
            "x": _w((lambda *s: torch.randn(*s, dtype=torch.bfloat16) * 0.05)(B, S, D)),
            "w1": _w((lambda *s: torch.randn(*s, dtype=torch.bfloat16) * 0.05)(D, Dff)),
            "w2": _w((lambda *s: torch.randn(*s, dtype=torch.bfloat16) * 0.05)(Dff, D)),
        }
    _B_in = _B_setup()

    return {
        "A_x": _A_in["x"],
        "A_wqkv": _A_in["wqkv"],
        "A_wo": _A_in["wo"],
        "B_x": _B_in["x"],
        "B_w1": _B_in["w1"],
        "B_w2": _B_in["w2"],
        "gate_w": _w((lambda *s: torch.randn(*s, dtype=torch.bfloat16) * 0.05)(512) * 16.0),
    }

def reference(A_x, A_wqkv, A_wo, B_x, B_w1, B_w2, gate_w):
    def _A_ref(x, wqkv, wo):
        B, S, D = x.shape
        H = 32; Dh = D // H; W = 256
        qkv = (lambda x, *d: x.permute(*d))((x @ wqkv).reshape(B, S, 3, H, Dh), 2, 0, 3, 1, 4)
        q, k, v = qkv[0], qkv[1], qkv[2]
        scores = torch.einsum("bhqd,bhkd->bhqk", q, k) * (Dh ** -0.5)
        idx = torch.arange(S)
        mask = (idx[:, None] - idx[None, :] >= 0) & (idx[:, None] - idx[None, :] < W)
        scores = torch.where(mask[None, None], scores, -1e9)
        p = _softmax(scores, axis=-1)
        o = torch.einsum("bhqk,bhkd->bhqd", p, v)
        return (lambda x, *d: x.permute(*d))(o, 0, 2, 1, 3).reshape(B, S, D) @ wo

    def _B_ref(x, w1, w2):
        h = torch.einsum("bsd,df->bsf", x, w1)
        zero = torch.zeros_like(h)
        h = torch.maximum(h, zero)
        return torch.einsum("bsf,fd->bsd", h, w2)

    x = A_x
    g = _sigmoid((x * gate_w).sum(-1, keepdims=True))
    a = _A_ref(x, A_wqkv, A_wo)
    b = _B_ref(x, B_w1, B_w2)
    return g * a + (1 - g) * b
```

```asm
; @launch grid=(256,1,1) block=(512,1,1) lds=163840
.amdgcn_target "amdgcn-amd-amdhsa--gfx950"
.text
.globl gated_mix__sliding_block__dense_activation_relu__prompt_kernel
.p2align 8
.type gated_mix__sliding_block__dense_activation_relu__prompt_kernel,@function
gated_mix__sliding_block__dense_activation_relu__prompt_kernel:
    s_cmp_ge_u32 s2, 256
    s_cbranch_scc1 .Lend
    s_load_dwordx16 s[16:31], s[0:1], 0
    s_load_dwordx4 s[32:35], s[0:1], 64
    v_lshrrev_b32 v1, 6, v0
    v_and_b32 v0, 63, v0
    v_readfirstlane_b32 s3, v1
    s_and_b32 s4, s2, 7
    s_lshr_b32 s5, s2, 3
    s_and_b32 s72, s4, 1
    s_lshr_b32 s73, s4, 1
    s_and_b32 s74, s5, 7
    s_lshr_b32 s75, s5, 3
    s_lshl_b32 s6, s72, 3
    s_add_u32 s6, s6, s74
    s_lshl_b32 s7, s73, 2
    s_add_u32 s7, s7, s75
    s_lshl_b32 s12, s75, 1
    s_add_u32 s12, s12, s74
    s_and_b32 s12, s12, 7
    s_lshl_b32 s8, s73, 3
    s_add_u32 s8, s8, s74
    s_lshl_b32 s9, s72, 2
    s_add_u32 s9, s9, s75
    s_lshl_b32 s10, s4, 2
    s_add_u32 s10, s10, s75
    s_mov_b32 s11, s74
    s_mov_b32 s13, 0
    s_and_b32 s14, s3, 3
    s_lshr_b32 s97, s5, 3
    s_lshr_b32 s96, s4, 1
    s_mul_i32 s95, s96, 12
    s_lshl_b32 s72, s97, 1
    s_add_u32 s72, s72, 6
    s_cmp_eq_u32 s97, 3
    s_cselect_b32 s72, 4, s72
    s_add_u32 s94, s95, s72
    s_lshl_b32 s93, s6, 2
    s_add_u32 s93, s93, s14
    s_cmp_lt_u32 s3, 4
    s_cbranch_scc1 .Lcompute
    v_mov_b32 v254, v0
    v_lshrrev_b32 v1, 3, v0
    v_and_b32 v2, 7, v0
    v_lshrrev_b32 v3, 4, v0
    s_lshl_b32 s72, s6, 7
    s_lshl_b32 s73, s14, 5
    s_add_u32 s72, s72, s73
    v_add_u32 v4, 0, v3
    v_xor_b32 v4, v4, v2
    v_lshlrev_b32 v4, 4, v4
    v_add_u32 v5, 0, v1
    v_add_u32 v5, s72, v5
    v_lshl_add_u32 v240, v5, 10, v4
    v_add_u32 v4, 4, v3
    v_xor_b32 v4, v4, v2
    v_lshlrev_b32 v4, 4, v4
    v_add_u32 v5, 8, v1
    v_add_u32 v5, s72, v5
    v_lshl_add_u32 v241, v5, 10, v4
    v_add_u32 v4, 0, v3
    v_xor_b32 v4, v4, v2
    v_lshlrev_b32 v4, 4, v4
    v_add_u32 v5, 16, v1
    v_add_u32 v5, s72, v5
    v_lshl_add_u32 v242, v5, 10, v4
    v_add_u32 v4, 4, v3
    v_xor_b32 v4, v4, v2
    v_lshlrev_b32 v4, 4, v4
    v_add_u32 v5, 24, v1
    v_add_u32 v5, s72, v5
    v_lshl_add_u32 v243, v5, 10, v4
    v_lshrrev_b32 v1, 2, v0
    s_lshl_b32 s72, s14, 4
    v_add_u32 v6, s72, v1
    v_and_b32 v2, 3, v0
    v_lshlrev_b32 v2, 4, v2
    s_cmp_eq_u32 s97, 3
    s_mov_b32 s86, 3072
    s_cselect_b32 s86, 2752, s86
    s_lshl_b32 s72, s97, 10
    s_lshl_b32 s73, s96, 8
    s_add_u32 s72, s72, s73
    s_lshl_b32 s73, s95, 6
    s_cmp_eq_u32 s97, 3
    s_cselect_b32 s72, s73, s72
    v_mul_lo_u32 v244, v6, s86
    v_add3_u32 v244, v244, v2, s72
    s_lshl_b32 s86, s86, 6
    s_lshl_b32 s78, s12, 7
    s_mul_i32 s79, s12, s86
    s_mul_i32 s80, s12, 176128
    s_lshl_b32 s81, s14, 12
    s_lshl_b32 s82, s14, 10
    s_waitcnt lgkmcnt(0)
    s_mov_b32 s36, s16
    s_mov_b32 s37, s17
    s_mov_b32 s38, 2097152
    s_mov_b32 s39, 0x00020000
    s_cmp_eq_u32 s97, 3
    s_cselect_b32 s40, s24, s18
    s_cselect_b32 s41, s25, s19
    s_mov_b32 s42, 1572864
    s_cselect_b32 s42, 1409024, s42
    s_mov_b32 s43, 0x00020000
    s_add_u32 m0, s81, 0
    s_nop 0
    buffer_load_dwordx4 v240, s[36:39], s78 offen lds
    s_add_u32 m0, s81, 1024
    s_nop 0
    buffer_load_dwordx4 v241, s[36:39], s78 offen lds
    s_add_u32 m0, s81, 2048
    s_nop 0
    buffer_load_dwordx4 v242, s[36:39], s78 offen lds
    s_add_u32 m0, s81, 3072
    s_nop 0
    buffer_load_dwordx4 v243, s[36:39], s78 offen lds
    s_add_u32 m0, s82, 65536
    s_nop 0
    buffer_load_dwordx4 v244, s[40:43], s79 offen offset:0 lds
    s_add_u32 m0, s82, 69568
    s_nop 0
    buffer_load_dwordx4 v244, s[40:43], s79 offen offset:64 lds
    s_add_u32 m0, s82, 73600
    s_nop 0
    buffer_load_dwordx4 v244, s[40:43], s79 offen offset:128 lds
    s_add_u32 m0, s82, 77632
    s_nop 0
    buffer_load_dwordx4 v244, s[40:43], s79 offen offset:192 lds
    s_add_u32 s78, s78, 128
    s_add_u32 s79, s79, s86
    s_cmp_eq_u32 s78, 1024
    s_cselect_b32 s78, 0, s78
    s_cselect_b32 s79, 0, s79
    s_add_u32 m0, s81, 16384
    s_nop 0
    buffer_load_dwordx4 v240, s[36:39], s78 offen lds
    s_add_u32 m0, s81, 17408
    s_nop 0
    buffer_load_dwordx4 v241, s[36:39], s78 offen lds
    s_add_u32 m0, s81, 18432
    s_nop 0
    buffer_load_dwordx4 v242, s[36:39], s78 offen lds
    s_add_u32 m0, s81, 19456
    s_nop 0
    buffer_load_dwordx4 v243, s[36:39], s78 offen lds
    s_add_u32 m0, s82, 81920
    s_nop 0
    buffer_load_dwordx4 v244, s[40:43], s79 offen offset:0 lds
    s_add_u32 m0, s82, 85952
    s_nop 0
    buffer_load_dwordx4 v244, s[40:43], s79 offen offset:64 lds
    s_add_u32 m0, s82, 89984
    s_nop 0
    buffer_load_dwordx4 v244, s[40:43], s79 offen offset:128 lds
    s_add_u32 m0, s82, 94016
    s_nop 0
    buffer_load_dwordx4 v244, s[40:43], s79 offen offset:192 lds
    s_add_u32 s78, s78, 128
    s_add_u32 s79, s79, s86
    s_cmp_eq_u32 s78, 1024
    s_cselect_b32 s78, 0, s78
    s_cselect_b32 s79, 0, s79
    s_mov_b32 s44, s34
    s_mov_b32 s45, s35
    s_mov_b32 s46, 23068672
    s_mov_b32 s47, 0x00020000
    s_mov_b32 s48, s24
    s_mov_b32 s49, s25
    s_mov_b32 s50, 1409024
    s_mov_b32 s51, 0x00020000
    s_mov_b32 s60, s30
    s_mov_b32 s61, s31
    s_mov_b32 s62, 2097152
    s_mov_b32 s63, 0x00020000
    s_lshl_b32 s72, s94, 6
    s_cmp_lt_u32 s94, 43
    s_cselect_b32 s72, s72, 0x40000000
    v_mul_u32_u24 v245, 2752, v6
    v_add3_u32 v245, v245, v2, s72
    v_lshlrev_b32 v247, 4, v0
    s_mov_b32 s64, s32
    s_mov_b32 s65, s33
    s_mov_b32 s66, 256
    s_mov_b32 s67, 0x00020000
    s_lshl_b32 s83, s5, 2
    s_add_u32 s83, s83, s14
    s_cmp_lt_u32 s83, 86
    s_cselect_b32 s52, s26, s20
    s_cselect_b32 s53, s27, s21
    s_mov_b32 s54, 1409024
    s_cselect_b32 s54, s54, 524288
    s_mov_b32 s55, 0x00020000
    s_cselect_b32 s84, 0, 86
    s_sub_u32 s84, s83, s84
    s_lshl_b32 s84, s84, 14
    s_lshl_b32 s85, s4, 7
    s_add_u32 s84, s84, s85
    v_lshlrev_b32 v8, 10, v1
    v_add_u32 v8, v8, v2
    s_lshl_b32 s85, s14, 11
    s_add_u32 s85, s85, 147456
    v_lshrrev_b32 v9, 5, v0
    v_lshlrev_b32 v9, 8, v9
    v_bfe_u32 v4, v0, 2, 2
    v_lshl_add_u32 v9, v4, 6, v9
    v_bfe_u32 v4, v0, 4, 1
    v_lshl_add_u32 v9, v4, 5, v9
    v_and_b32 v4, 3, v0
    v_lshl_add_u32 v9, v4, 3, v9
    v_add_u32 v9, s85, v9
    v_mov_b32 v10, 0
    s_waitcnt vmcnt(8)
    s_barrier
    s_add_u32 m0, s81, 32768
    s_nop 0
    buffer_load_dwordx4 v240, s[36:39], s78 offen lds
    s_add_u32 m0, s81, 33792
    s_nop 0
    buffer_load_dwordx4 v241, s[36:39], s78 offen lds
    s_add_u32 m0, s81, 34816
    s_nop 0
    buffer_load_dwordx4 v242, s[36:39], s78 offen lds
    s_add_u32 m0, s81, 35840
    s_nop 0
    buffer_load_dwordx4 v243, s[36:39], s78 offen lds
    s_add_u32 m0, s82, 98304
    s_nop 0
    buffer_load_dwordx4 v244, s[40:43], s79 offen offset:0 lds
    s_add_u32 m0, s82, 102336
    s_nop 0
    buffer_load_dwordx4 v244, s[40:43], s79 offen offset:64 lds
    s_add_u32 m0, s82, 106368
    s_nop 0
    buffer_load_dwordx4 v244, s[40:43], s79 offen offset:128 lds
    s_add_u32 m0, s82, 110400
    s_nop 0
    buffer_load_dwordx4 v244, s[40:43], s79 offen offset:192 lds
    s_add_u32 s78, s78, 128
    s_add_u32 s79, s79, s86
    s_cmp_eq_u32 s78, 1024
    s_cselect_b32 s78, 0, s78
    s_cselect_b32 s79, 0, s79
    s_add_u32 m0, s81, 49152
    s_nop 0
    buffer_load_dwordx4 v240, s[36:39], s78 offen lds
    s_add_u32 m0, s81, 50176
    s_nop 0
    buffer_load_dwordx4 v241, s[36:39], s78 offen lds
    s_add_u32 m0, s81, 51200
    s_nop 0
    buffer_load_dwordx4 v242, s[36:39], s78 offen lds
    s_add_u32 m0, s81, 52224
    s_nop 0
    buffer_load_dwordx4 v243, s[36:39], s78 offen lds
    s_add_u32 m0, s82, 114688
    s_nop 0
    buffer_load_dwordx4 v244, s[40:43], s79 offen offset:0 lds
    s_add_u32 m0, s82, 118720
    s_nop 0
    buffer_load_dwordx4 v244, s[40:43], s79 offen offset:64 lds
    s_add_u32 m0, s82, 122752
    s_nop 0
    buffer_load_dwordx4 v244, s[40:43], s79 offen offset:128 lds
    s_add_u32 m0, s82, 126784
    s_nop 0
    buffer_load_dwordx4 v244, s[40:43], s79 offen offset:192 lds
    s_add_u32 s78, s78, 128
    s_add_u32 s79, s79, s86
    s_cmp_eq_u32 s78, 1024
    s_cselect_b32 s78, 0, s78
    s_cselect_b32 s79, 0, s79
    s_add_u32 m0, s82, 131072
    s_nop 0
    buffer_load_dwordx4 v245, s[48:51], s80 offen offset:0 lds
    s_add_u32 m0, s82, 135104
    s_nop 0
    buffer_load_dwordx4 v245, s[48:51], s80 offen offset:64 lds
    s_add_u32 s80, s80, 176128
    s_cmp_eq_u32 s80, 1409024
    s_cselect_b32 s80, 0, s80
    s_waitcnt vmcnt(18)
    s_barrier
    s_add_u32 m0, s81, 0
    s_nop 0
    buffer_load_dwordx4 v240, s[36:39], s78 offen lds
    s_add_u32 m0, s81, 1024
    s_nop 0
    buffer_load_dwordx4 v241, s[36:39], s78 offen lds
    s_add_u32 m0, s81, 2048
    s_nop 0
    buffer_load_dwordx4 v242, s[36:39], s78 offen lds
    s_add_u32 m0, s81, 3072
    s_nop 0
    buffer_load_dwordx4 v243, s[36:39], s78 offen lds
    s_add_u32 m0, s82, 65536
    s_nop 0
    buffer_load_dwordx4 v244, s[40:43], s79 offen offset:0 lds
    s_add_u32 m0, s82, 69568
    s_nop 0
    buffer_load_dwordx4 v244, s[40:43], s79 offen offset:64 lds
    s_add_u32 m0, s82, 73600
    s_nop 0
    buffer_load_dwordx4 v244, s[40:43], s79 offen offset:128 lds
    s_add_u32 m0, s82, 77632
    s_nop 0
    buffer_load_dwordx4 v244, s[40:43], s79 offen offset:192 lds
    s_add_u32 s78, s78, 128
    s_add_u32 s79, s79, s86
    s_cmp_eq_u32 s78, 1024
    s_cselect_b32 s78, 0, s78
    s_cselect_b32 s79, 0, s79
    s_waitcnt vmcnt(18)
    s_barrier
    s_add_u32 m0, s81, 16384
    s_nop 0
    buffer_load_dwordx4 v240, s[36:39], s78 offen lds
    s_add_u32 m0, s81, 17408
    s_nop 0
    buffer_load_dwordx4 v241, s[36:39], s78 offen lds
    s_add_u32 m0, s81, 18432
    s_nop 0
    buffer_load_dwordx4 v242, s[36:39], s78 offen lds
    s_add_u32 m0, s81, 19456
    s_nop 0
    buffer_load_dwordx4 v243, s[36:39], s78 offen lds
    s_add_u32 m0, s82, 81920
    s_nop 0
    buffer_load_dwordx4 v244, s[40:43], s79 offen offset:0 lds
    s_add_u32 m0, s82, 85952
    s_nop 0
    buffer_load_dwordx4 v244, s[40:43], s79 offen offset:64 lds
    s_add_u32 m0, s82, 89984
    s_nop 0
    buffer_load_dwordx4 v244, s[40:43], s79 offen offset:128 lds
    s_add_u32 m0, s82, 94016
    s_nop 0
    buffer_load_dwordx4 v244, s[40:43], s79 offen offset:192 lds
    s_add_u32 s78, s78, 128
    s_add_u32 s79, s79, s86
    s_cmp_eq_u32 s78, 1024
    s_cselect_b32 s78, 0, s78
    s_cselect_b32 s79, 0, s79
    s_waitcnt vmcnt(18)
    s_barrier
    s_add_u32 m0, s81, 32768
    s_nop 0
    buffer_load_dwordx4 v240, s[36:39], s78 offen lds
    s_add_u32 m0, s81, 33792
    s_nop 0
    buffer_load_dwordx4 v241, s[36:39], s78 offen lds
    s_add_u32 m0, s81, 34816
    s_nop 0
    buffer_load_dwordx4 v242, s[36:39], s78 offen lds
    s_add_u32 m0, s81, 35840
    s_nop 0
    buffer_load_dwordx4 v243, s[36:39], s78 offen lds
    s_add_u32 m0, s82, 98304
    s_nop 0
    buffer_load_dwordx4 v244, s[40:43], s79 offen offset:0 lds
    s_add_u32 m0, s82, 102336
    s_nop 0
    buffer_load_dwordx4 v244, s[40:43], s79 offen offset:64 lds
    s_add_u32 m0, s82, 106368
    s_nop 0
    buffer_load_dwordx4 v244, s[40:43], s79 offen offset:128 lds
    s_add_u32 m0, s82, 110400
    s_nop 0
    buffer_load_dwordx4 v244, s[40:43], s79 offen offset:192 lds
    s_add_u32 s78, s78, 128
    s_add_u32 s79, s79, s86
    s_cmp_eq_u32 s78, 1024
    s_cselect_b32 s78, 0, s78
    s_cselect_b32 s79, 0, s79
    s_mov_b32 m0, s85
    s_nop 0
    buffer_load_dwordx4 v8, s[52:55], s84 offen lds
    s_add_u32 m0, s85, 960
    s_nop 0
    buffer_load_dwordx4 v8, s[52:55], s84 offen offset:64 lds
    s_waitcnt vmcnt(18)
    s_barrier
    s_add_u32 m0, s81, 49152
    s_nop 0
    buffer_load_dwordx4 v240, s[36:39], s78 offen lds
    s_add_u32 m0, s81, 50176
    s_nop 0
    buffer_load_dwordx4 v241, s[36:39], s78 offen lds
    s_add_u32 m0, s81, 51200
    s_nop 0
    buffer_load_dwordx4 v242, s[36:39], s78 offen lds
    s_add_u32 m0, s81, 52224
    s_nop 0
    buffer_load_dwordx4 v243, s[36:39], s78 offen lds
    s_add_u32 m0, s82, 114688
    s_nop 0
    buffer_load_dwordx4 v244, s[40:43], s79 offen offset:0 lds
    s_add_u32 m0, s82, 118720
    s_nop 0
    buffer_load_dwordx4 v244, s[40:43], s79 offen offset:64 lds
    s_add_u32 m0, s82, 122752
    s_nop 0
    buffer_load_dwordx4 v244, s[40:43], s79 offen offset:128 lds
    s_add_u32 m0, s82, 126784
    s_nop 0
    buffer_load_dwordx4 v244, s[40:43], s79 offen offset:192 lds
    s_add_u32 s78, s78, 128
    s_add_u32 s79, s79, s86
    s_cmp_eq_u32 s78, 1024
    s_cselect_b32 s78, 0, s78
    s_cselect_b32 s79, 0, s79
    buffer_load_dword v11, v10, s[64:67], 0 offen sc1
    s_add_u32 m0, s82, 139264
    s_nop 0
    buffer_load_dwordx4 v245, s[48:51], s80 offen offset:0 lds
    s_add_u32 m0, s82, 143296
    s_nop 0
    buffer_load_dwordx4 v245, s[48:51], s80 offen offset:64 lds
    s_add_u32 s80, s80, 176128
    s_cmp_eq_u32 s80, 1409024
    s_cselect_b32 s80, 0, s80
    s_waitcnt vmcnt(21)
    s_barrier
    s_add_u32 m0, s82, 0
    s_nop 0
    buffer_load_dwordx4 v245, s[48:51], s80 offen offset:0 lds
    s_add_u32 m0, s82, 4032
    s_nop 0
    buffer_load_dwordx4 v245, s[48:51], s80 offen offset:64 lds
    s_add_u32 s80, s80, 176128
    s_cmp_eq_u32 s80, 1409024
    s_cselect_b32 s80, 0, s80
    s_add_u32 m0, s82, 8192
    s_nop 0
    buffer_load_dwordx4 v245, s[48:51], s80 offen offset:0 lds
    s_add_u32 m0, s82, 12224
    s_nop 0
    buffer_load_dwordx4 v245, s[48:51], s80 offen offset:64 lds
    s_add_u32 s80, s80, 176128
    s_cmp_eq_u32 s80, 1409024
    s_cselect_b32 s80, 0, s80
    s_add_u32 m0, s82, 73728
    s_nop 0
    buffer_load_dwordx4 v245, s[48:51], s80 offen offset:0 lds
    s_add_u32 m0, s82, 77760
    s_nop 0
    buffer_load_dwordx4 v245, s[48:51], s80 offen offset:64 lds
    s_add_u32 s80, s80, 176128
    s_cmp_eq_u32 s80, 1409024
    s_cselect_b32 s80, 0, s80
    s_waitcnt vmcnt(19)
    s_barrier
    s_add_u32 m0, s82, 16384
    s_nop 0
    buffer_load_dwordx4 v245, s[48:51], s80 offen offset:0 lds
    s_add_u32 m0, s82, 20416
    s_nop 0
    buffer_load_dwordx4 v245, s[48:51], s80 offen offset:64 lds
    s_add_u32 s80, s80, 176128
    s_cmp_eq_u32 s80, 1409024
    s_cselect_b32 s80, 0, s80
    s_add_u32 m0, s82, 24576
    s_nop 0
    buffer_load_dwordx4 v245, s[48:51], s80 offen offset:0 lds
    s_add_u32 m0, s82, 28608
    s_nop 0
    buffer_load_dwordx4 v245, s[48:51], s80 offen offset:64 lds
    s_add_u32 s80, s80, 176128
    s_cmp_eq_u32 s80, 1409024
    s_cselect_b32 s80, 0, s80
    s_add_u32 m0, s82, 81920
    s_nop 0
    buffer_load_dwordx4 v245, s[48:51], s80 offen offset:0 lds
    s_add_u32 m0, s82, 85952
    s_nop 0
    buffer_load_dwordx4 v245, s[48:51], s80 offen offset:64 lds
    s_add_u32 s80, s80, 176128
    s_cmp_eq_u32 s80, 1409024
    s_cselect_b32 s80, 0, s80
    s_waitcnt vmcnt(15)
    s_barrier
    s_waitcnt vmcnt(14)
    v_readfirstlane_b32 s13, v11
    s_cmp_lg_u32 s13, 0
    s_cbranch_scc1 .Lnonce_ok
    s_mov_b32 s74, 16384
.Lnonce_poll:
    s_sleep 1
    buffer_load_dword v11, v10, s[64:67], 0 offen sc1
    s_waitcnt vmcnt(0)
    v_readfirstlane_b32 s13, v11
    s_cmp_lg_u32 s13, 0
    s_cbranch_scc1 .Lnonce_ok
    s_sub_u32 s74, s74, 1
    s_cmp_lg_u32 s74, 0
    s_cbranch_scc1 .Lnonce_poll
.Lnonce_ok:
    v_mov_b32 v4, 155648
    ds_write_b32 v4, v11
    ds_write_b32 v4, v10 offset:4
    ds_write_b32 v4, v10 offset:8
    ds_write_b32 v4, v10 offset:12
    ds_write_b32 v4, v10 offset:16
    ds_write_b32 v4, v10 offset:20
    ds_write_b32 v4, v10 offset:24
    ds_write_b32 v4, v10 offset:28
    s_waitcnt lgkmcnt(0)
    v_lshlrev_b32 v250, 2, v254
    ds_read_b64_tr_b16 v[12:13], v9 offset:0
    ds_read_b64_tr_b16 v[14:15], v9 offset:512
    ds_read_b64_tr_b16 v[16:17], v9 offset:1024
    ds_read_b64_tr_b16 v[18:19], v9 offset:1536
    s_mul_i32 s84, s4, 236
    s_add_u32 s84, s84, s83
    s_lshl_b32 s84, s84, 10
    s_add_u32 s84, s84, 14680064
    s_cmp_lt_u32 s83, 118
    s_cselect_b32 s84, s84, 0x40000000
    s_add_u32 s85, s84, 120832
    s_waitcnt lgkmcnt(0)
    buffer_store_dwordx4 v[12:15], v247, s[44:47], s84 offen sc1
    buffer_store_dwordx4 v[16:19], v247, s[44:47], s85 offen sc1
    s_lshl_b32 s90, s4, 7
    s_add_u32 s90, s90, s83
    s_lshl_b32 s90, s90, 2
    s_add_u32 s90, s90, 16863232
    s_waitcnt vmcnt(10)
    s_barrier
    s_waitcnt vmcnt(2)
    s_barrier
    s_mov_b32 s85, 0
    s_waitcnt vmcnt(0)
    s_mov_b64 exec, 1
    v_mov_b32 v251, 0
    v_mov_b32 v252, s13
    buffer_store_dword v252, v251, s[44:47], s90 offen sc1
    s_mov_b64 exec, -1
    s_cmp_lg_u32 s3, 4
    s_cbranch_scc1 .Lfa_wait
    s_lshr_b32 s76, s8, 2
    s_lshl_b32 s76, s76, 9
    s_lshl_b32 s77, s9, 6
    s_add_u32 s76, s76, s77
    s_add_u32 s76, s76, 16842688
    s_add_u32 s77, s76, 0x1000
    s_mov_b32 s84, 0x77776666
    s_cmp_eq_u32 s9, 0
    s_cselect_b32 s84, 0x77770000, s84
    s_cmp_eq_u32 s9, 4
    s_cselect_b32 s75, 0, 3
    s_mov_b32 s74, 16384
    s_mov_b32 exec_hi, 0
.Lfa_poll:
    buffer_load_dword v251, v250, s[44:47], s77 offen sc1
    s_waitcnt vmcnt(0)
    v_cmp_ne_u32 vcc, s13, v251
    s_and_b64 s[84:85], vcc, s[84:85]
    s_cbranch_scc0 .Lfa_ok
    s_and_b32 s72, s74, s75
    s_cmp_lg_u32 s72, 0
    s_cbranch_scc1 .Lfa_skipg
    buffer_load_dword v252, v250, s[44:47], s76 offen sc1
    s_waitcnt vmcnt(0)
    v_cmp_ne_u32 vcc, s13, v252
    s_and_b64 s[84:85], vcc, s[84:85]
    s_cbranch_scc0 .Lfa_ok
.Lfa_skipg:
    s_sleep 1
    s_sub_u32 s74, s74, 1
    s_cmp_lg_u32 s74, 0
    s_cbranch_scc1 .Lfa_poll
.Lfa_ok:
    s_mov_b64 exec, -1
    v_mov_b32 v251, 155656
    v_mov_b32 v252, 1
    ds_write_b32 v251, v252
    s_branch .Lfa_go
.Lfa_wait:
    v_mov_b32 v251, 155656
    s_mov_b32 s74, 262144
.Lfa_lw:
    ds_read_b32 v252, v251
    s_waitcnt lgkmcnt(0)
    v_readfirstlane_b32 s72, v252
    s_cmp_lg_u32 s72, 0
    s_cbranch_scc1 .Lfa_lok
    s_sleep 1
    s_sub_u32 s74, s74, 1
    s_cmp_lg_u32 s74, 0
    s_cbranch_scc1 .Lfa_lw
.Lfa_lok:
.Lfa_go:
    s_lshl_b32 s72, s8, 6
    s_lshl_b32 s73, s9, 3
    s_add_u32 s72, s72, s73
    s_lshl_b32 s72, s72, 10
    s_lshl_b32 s73, s14, 11
    s_add_u32 s73, s73, s72
    s_add_u32 s74, s72, s81
    s_add_u32 s74, s74, 2088960
    s_lshl_b32 s75, s9, 2
    s_add_u32 s75, s75, s14
    s_cmp_lt_u32 s75, 2
    s_cselect_b32 s74, 0x40000000, s74
    s_add_u32 s75, s74, 2097152
    s_add_u32 m0, s81, 32768
    s_nop 0
    buffer_load_dwordx4 v247, s[44:47], s74 offen offset:0 lds
    buffer_load_dwordx4 v247, s[44:47], s74 offen offset:1024 lds
    buffer_load_dwordx4 v247, s[44:47], s74 offen offset:2048 lds
    buffer_load_dwordx4 v247, s[44:47], s74 offen offset:3072 lds
    s_lshl_b32 s74, s14, 11
    s_add_u32 m0, s74, 65536
    s_nop 0
    buffer_load_dwordx4 v247, s[44:47], s73 offen offset:0 lds
    buffer_load_dwordx4 v247, s[44:47], s73 offen offset:1024 lds
    s_add_u32 m0, s81, 49152
    s_nop 0
    buffer_load_dwordx4 v247, s[44:47], s75 offen offset:0 lds
    buffer_load_dwordx4 v247, s[44:47], s75 offen offset:1024 lds
    buffer_load_dwordx4 v247, s[44:47], s75 offen offset:2048 lds
    buffer_load_dwordx4 v247, s[44:47], s75 offen offset:3072 lds
    s_mul_i32 s86, s14, 22
    s_cmp_eq_u32 s14, 3
    s_cselect_b32 s86, 65, s86
    s_add_u32 s87, s86, 22
    s_cmp_ge_u32 s14, 2
    s_cselect_b32 s88, 1, 0
    s_sub_u32 s87, s87, s88
    s_mul_i32 s92, s11, 3
    s_mul_i32 s72, s97, 5
    s_add_u32 s92, s92, s72
    s_cmp_ge_u32 s92, 22
    s_cselect_b32 s72, 22, 0
    s_sub_u32 s92, s92, s72
    s_lshl_b32 s92, s92, 10
    s_mov_b32 s93, s92
    s_mul_i32 s72, s11, 236
    s_add_u32 s72, s72, s86
    s_lshl_b32 s72, s72, 10
    s_add_u32 s72, s72, 14680064
    v_add_u32 v248, s72, v247
    v_add_u32 v249, 120832, v248
    s_mul_i32 s72, s10, 241664
    s_add_u32 s72, s72, 6291456
    s_lshl_b32 s73, s87, 10
    s_add_u32 s76, s34, s72
    s_addc_u32 s77, s35, 0
    s_mov_b32 s78, s73
    s_mov_b32 s79, 0x00020000
    s_add_u32 s72, s72, 120832
    s_add_u32 s80, s34, s72
    s_addc_u32 s81, s35, 0
    s_mov_b32 s82, s73
    s_mov_b32 s83, 0x00020000
    s_add_u32 s72, s72, 120832
    s_lshl_b32 s89, s14, 14
    s_cmp_ge_u32 s14, 2
    s_cselect_b32 s72, 65536, 0
    s_add_u32 s89, s89, s72
    s_lshl_b32 s91, s11, 7
    s_add_u32 s91, s91, s86
    s_lshl_b32 s91, s91, 2
    s_add_u32 s91, s91, 16863232
    s_mov_b32 s84, 0x3fffff
    s_mov_b32 s85, 0
    s_mov_b32 exec_hi, 0
    buffer_load_dword v251, v250, s[44:47], s91 offen sc1
    s_waitcnt vmcnt(1)
    v_mov_b32 v252, 155668
    v_mov_b32 v253, 1
    s_mov_b64 exec, 1
    ds_add_u32 v252, v253
    s_mov_b32 exec_lo, -1
    s_waitcnt vmcnt(0)
    v_cmp_ne_u32 vcc, s13, v251
    s_and_b64 s[72:73], vcc, s[84:85]
    s_cbranch_scc0 .Lfw_ok
    s_mov_b32 s74, 16384
.Lfw_poll:
    buffer_load_dword v251, v250, s[44:47], s91 offen sc1
    s_waitcnt vmcnt(0)
    v_cmp_ne_u32 vcc, s13, v251
    s_and_b64 s[72:73], vcc, s[84:85]
    s_cbranch_scc0 .Lfw_ok
    s_sleep 2
    s_sub_u32 s74, s74, 1
    s_cmp_lg_u32 s74, 0
    s_cbranch_scc1 .Lfw_poll
.Lfw_ok:
    s_mov_b64 exec, -1
    buffer_load_dwordx4 v[0:3], v248, s[44:47], s92 offen
    buffer_load_dwordx4 v[4:7], v249, s[44:47], s92 offen
    s_add_u32 s92, s92, 1024
    s_cmp_eq_u32 s92, 22528
    s_cselect_b32 s92, 0, s92
    buffer_load_dwordx4 v[8:11], v248, s[44:47], s92 offen
    buffer_load_dwordx4 v[12:15], v249, s[44:47], s92 offen
    s_add_u32 s92, s92, 1024
    s_cmp_eq_u32 s92, 22528
    s_cselect_b32 s92, 0, s92
    buffer_load_dwordx4 v[16:19], v248, s[44:47], s92 offen
    buffer_load_dwordx4 v[20:23], v249, s[44:47], s92 offen
    s_add_u32 s92, s92, 1024
    s_cmp_eq_u32 s92, 22528
    s_cselect_b32 s92, 0, s92
    buffer_load_dwordx4 v[24:27], v248, s[44:47], s92 offen
    buffer_load_dwordx4 v[28:31], v249, s[44:47], s92 offen
    s_add_u32 s92, s92, 1024
    s_cmp_eq_u32 s92, 22528
    s_cselect_b32 s92, 0, s92
    buffer_load_dwordx4 v[32:35], v248, s[44:47], s92 offen
    buffer_load_dwordx4 v[36:39], v249, s[44:47], s92 offen
    s_add_u32 s92, s92, 1024
    s_cmp_eq_u32 s92, 22528
    s_cselect_b32 s92, 0, s92
    buffer_load_dwordx4 v[40:43], v248, s[44:47], s92 offen
    buffer_load_dwordx4 v[44:47], v249, s[44:47], s92 offen
    s_add_u32 s92, s92, 1024
    s_cmp_eq_u32 s92, 22528
    s_cselect_b32 s92, 0, s92
    buffer_load_dwordx4 v[48:51], v248, s[44:47], s92 offen
    buffer_load_dwordx4 v[52:55], v249, s[44:47], s92 offen
    s_add_u32 s92, s92, 1024
    s_cmp_eq_u32 s92, 22528
    s_cselect_b32 s92, 0, s92
    buffer_load_dwordx4 v[56:59], v248, s[44:47], s92 offen
    buffer_load_dwordx4 v[60:63], v249, s[44:47], s92 offen
    s_add_u32 s92, s92, 1024
    s_cmp_eq_u32 s92, 22528
    s_cselect_b32 s92, 0, s92
    buffer_load_dwordx4 v[64:67], v248, s[44:47], s92 offen
    buffer_load_dwordx4 v[68:71], v249, s[44:47], s92 offen
    s_add_u32 s92, s92, 1024
    s_cmp_eq_u32 s92, 22528
    s_cselect_b32 s92, 0, s92
    buffer_load_dwordx4 v[72:75], v248, s[44:47], s92 offen
    buffer_load_dwordx4 v[76:79], v249, s[44:47], s92 offen
    s_add_u32 s92, s92, 1024
    s_cmp_eq_u32 s92, 22528
    s_cselect_b32 s92, 0, s92
    buffer_load_dwordx4 v[80:83], v248, s[44:47], s92 offen
    buffer_load_dwordx4 v[84:87], v249, s[44:47], s92 offen
    s_add_u32 s92, s92, 1024
    s_cmp_eq_u32 s92, 22528
    s_cselect_b32 s92, 0, s92
    buffer_load_dwordx4 v[88:91], v248, s[44:47], s92 offen
    buffer_load_dwordx4 v[92:95], v249, s[44:47], s92 offen
    s_add_u32 s92, s92, 1024
    s_cmp_eq_u32 s92, 22528
    s_cselect_b32 s92, 0, s92
    buffer_load_dwordx4 v[96:99], v248, s[44:47], s92 offen
    buffer_load_dwordx4 v[100:103], v249, s[44:47], s92 offen
    s_add_u32 s92, s92, 1024
    s_cmp_eq_u32 s92, 22528
    s_cselect_b32 s92, 0, s92
    buffer_load_dwordx4 v[104:107], v248, s[44:47], s92 offen
    buffer_load_dwordx4 v[108:111], v249, s[44:47], s92 offen
    s_add_u32 s92, s92, 1024
    s_cmp_eq_u32 s92, 22528
    s_cselect_b32 s92, 0, s92
    buffer_load_dwordx4 v[112:115], v248, s[44:47], s92 offen
    buffer_load_dwordx4 v[116:119], v249, s[44:47], s92 offen
    s_add_u32 s92, s92, 1024
    s_cmp_eq_u32 s92, 22528
    s_cselect_b32 s92, 0, s92
    buffer_load_dwordx4 v[120:123], v248, s[44:47], s92 offen
    buffer_load_dwordx4 v[124:127], v249, s[44:47], s92 offen
    s_add_u32 s92, s92, 1024
    s_cmp_eq_u32 s92, 22528
    s_cselect_b32 s92, 0, s92
    buffer_load_dwordx4 v[128:131], v248, s[44:47], s92 offen
    buffer_load_dwordx4 v[132:135], v249, s[44:47], s92 offen
    s_add_u32 s92, s92, 1024
    s_cmp_eq_u32 s92, 22528
    s_cselect_b32 s92, 0, s92
    buffer_load_dwordx4 v[136:139], v248, s[44:47], s92 offen
    buffer_load_dwordx4 v[140:143], v249, s[44:47], s92 offen
    s_add_u32 s92, s92, 1024
    s_cmp_eq_u32 s92, 22528
    s_cselect_b32 s92, 0, s92
    buffer_load_dwordx4 v[144:147], v248, s[44:47], s92 offen
    buffer_load_dwordx4 v[148:151], v249, s[44:47], s92 offen
    s_add_u32 s92, s92, 1024
    s_cmp_eq_u32 s92, 22528
    s_cselect_b32 s92, 0, s92
    buffer_load_dwordx4 v[152:155], v248, s[44:47], s92 offen
    buffer_load_dwordx4 v[156:159], v249, s[44:47], s92 offen
    s_add_u32 s92, s92, 1024
    s_cmp_eq_u32 s92, 22528
    s_cselect_b32 s92, 0, s92
    s_lshl_b32 s91, s10, 7
    s_add_u32 s91, s91, 16850944
    s_mov_b32 s84, -1
    s_cmp_lg_u32 s3, 4
    s_cbranch_scc1 .Lfb_wait
    s_mov_b32 exec_hi, 0
    s_mov_b32 s74, 16384
.Lfb_poll:
    buffer_load_dword v251, v250, s[44:47], s91 offen sc1
    s_waitcnt vmcnt(0)
    v_cmp_ne_u32 vcc, s13, v251
    s_and_b64 s[72:73], vcc, s[84:85]
    s_cbranch_scc0 .Lfb_ok
    s_sleep 2
    s_sub_u32 s74, s74, 1
    s_cmp_lg_u32 s74, 0
    s_cbranch_scc1 .Lfb_poll
.Lfb_ok:
    s_mov_b64 exec, -1
    v_mov_b32 v251, 155672
    s_mov_b32 s74, 262144
.Lbd_cw:
    ds_read_b32 v252, v251
    s_waitcnt lgkmcnt(0)
    v_readfirstlane_b32 s72, v252
    s_cmp_eq_u32 s72, 4
    s_cbranch_scc1 .Lbd_cok
    s_sleep 1
    s_sub_u32 s74, s74, 1
    s_cmp_lg_u32 s74, 0
    s_cbranch_scc1 .Lbd_cw
.Lbd_cok:
    v_mov_b32 v251, 155660
    v_mov_b32 v252, 1
    ds_write_b32 v251, v252
    s_branch .Lfb_go
.Lfb_wait:
    v_mov_b32 v251, 155660
    s_mov_b32 s74, 262144
.Lfb_lw:
    ds_read_b32 v252, v251
    s_waitcnt lgkmcnt(0)
    v_readfirstlane_b32 s72, v252
    s_cmp_lg_u32 s72, 0
    s_cbranch_scc1 .Lfb_lok
    s_sleep 1
    s_sub_u32 s74, s74, 1
    s_cmp_lg_u32 s74, 0
    s_cbranch_scc1 .Lfb_lw
.Lfb_lok:
.Lfb_go:
    s_lshl_b32 s72, s86, 10
    v_add_u32 v252, s72, v247
    v_add_u32 v253, s89, v247
    s_add_u32 m0, s89, 0
    s_nop 0
    buffer_load_dwordx4 v252, s[76:79], s93 offen lds
    s_add_u32 m0, s89, 1024
    s_nop 0
    buffer_load_dwordx4 v252, s[80:83], s93 offen lds
    s_add_u32 s93, s93, 1024
    s_cmp_eq_u32 s93, 22528
    s_cselect_b32 s93, 0, s93
    s_add_u32 m0, s89, 2048
    s_nop 0
    buffer_load_dwordx4 v252, s[76:79], s93 offen lds
    s_add_u32 m0, s89, 3072
    s_nop 0
    buffer_load_dwordx4 v252, s[80:83], s93 offen lds
    s_add_u32 s93, s93, 1024
    s_cmp_eq_u32 s93, 22528
    s_cselect_b32 s93, 0, s93
    s_add_u32 m0, s89, 4096
    s_nop 0
    buffer_load_dwordx4 v252, s[76:79], s93 offen lds
    s_add_u32 m0, s89, 5120
    s_nop 0
    buffer_load_dwordx4 v252, s[80:83], s93 offen lds
    s_add_u32 s93, s93, 1024
    s_cmp_eq_u32 s93, 22528
    s_cselect_b32 s93, 0, s93
    s_add_u32 m0, s89, 6144
    s_nop 0
    buffer_load_dwordx4 v252, s[76:79], s93 offen lds
    s_add_u32 m0, s89, 7168
    s_nop 0
    buffer_load_dwordx4 v252, s[80:83], s93 offen lds
    s_add_u32 s93, s93, 1024
    s_cmp_eq_u32 s93, 22528
    s_cselect_b32 s93, 0, s93
    s_add_u32 m0, s89, 8192
    s_nop 0
    buffer_load_dwordx4 v252, s[76:79], s93 offen lds
    s_add_u32 m0, s89, 9216
    s_nop 0
    buffer_load_dwordx4 v252, s[80:83], s93 offen lds
    s_add_u32 s93, s93, 1024
    s_cmp_eq_u32 s93, 22528
    s_cselect_b32 s93, 0, s93
    s_add_u32 m0, s89, 10240
    s_nop 0
    buffer_load_dwordx4 v252, s[76:79], s93 offen lds
    s_add_u32 m0, s89, 11264
    s_nop 0
    buffer_load_dwordx4 v252, s[80:83], s93 offen lds
    s_add_u32 s93, s93, 1024
    s_cmp_eq_u32 s93, 22528
    s_cselect_b32 s93, 0, s93
    s_add_u32 m0, s89, 12288
    s_nop 0
    buffer_load_dwordx4 v252, s[76:79], s93 offen lds
    s_add_u32 m0, s89, 13312
    s_nop 0
    buffer_load_dwordx4 v252, s[80:83], s93 offen lds
    s_add_u32 s93, s93, 1024
    s_cmp_eq_u32 s93, 22528
    s_cselect_b32 s93, 0, s93
    s_add_u32 m0, s89, 14336
    s_nop 0
    buffer_load_dwordx4 v252, s[76:79], s93 offen lds
    s_add_u32 m0, s89, 15360
    s_nop 0
    buffer_load_dwordx4 v252, s[80:83], s93 offen lds
    s_add_u32 s93, s93, 1024
    s_cmp_eq_u32 s93, 22528
    s_cselect_b32 s93, 0, s93
    v_and_b32 v250, 31, v254
    v_lshlrev_b32 v250, 2, v250
    s_lshl_b32 s72, s10, 8
    s_add_u32 s72, s72, 16777216
    buffer_load_dword v240, v250, s[44:47], s72 offen
    buffer_load_dword v241, v250, s[44:47], s72 offen offset:128
    s_waitcnt vmcnt(16)
    ds_read_b128 v[224:227], v253 offset:0
    ds_read_b128 v[228:231], v253 offset:1024
    s_waitcnt vmcnt(14)
    s_waitcnt lgkmcnt(0)
    v_mfma_f32_32x32x16_bf16 v[160:175], v[0:3], v[224:227], 0
    ds_read_b128 v[232:235], v253 offset:2048
    v_mfma_f32_32x32x16_bf16 v[176:191], v[0:3], v[228:231], 0
    ds_read_b128 v[236:239], v253 offset:3072
    v_mfma_f32_32x32x16_bf16 v[192:207], v[4:7], v[224:227], 0
    v_mfma_f32_32x32x16_bf16 v[208:223], v[4:7], v[228:231], 0
    s_add_u32 m0, s89, 0
    s_nop 0
    buffer_load_dwordx4 v252, s[76:79], s93 offen lds
    s_add_u32 m0, s89, 1024
    s_nop 0
    buffer_load_dwordx4 v252, s[80:83], s93 offen lds
    s_add_u32 s93, s93, 1024
    s_cmp_eq_u32 s93, 22528
    s_cselect_b32 s93, 0, s93
    buffer_load_dwordx4 v[0:3], v248, s[44:47], s92 offen
    buffer_load_dwordx4 v[4:7], v249, s[44:47], s92 offen
    s_add_u32 s92, s92, 1024
    s_cmp_eq_u32 s92, 22528
    s_cselect_b32 s92, 0, s92
    s_waitcnt vmcnt(16)
    s_waitcnt lgkmcnt(0)
    v_mfma_f32_32x32x16_bf16 v[160:175], v[8:11], v[232:235], v[160:175]
    ds_read_b128 v[224:227], v253 offset:4096
    v_mfma_f32_32x32x16_bf16 v[176:191], v[8:11], v[236:239], v[176:191]
    ds_read_b128 v[228:231], v253 offset:5120
    v_mfma_f32_32x32x16_bf16 v[192:207], v[12:15], v[232:235], v[192:207]
    v_mfma_f32_32x32x16_bf16 v[208:223], v[12:15], v[236:239], v[208:223]
    s_add_u32 m0, s89, 2048
    s_nop 0
    buffer_load_dwordx4 v252, s[76:79], s93 offen lds
    s_add_u32 m0, s89, 3072
    s_nop 0
    buffer_load_dwordx4 v252, s[80:83], s93 offen lds
    s_add_u32 s93, s93, 1024
    s_cmp_eq_u32 s93, 22528
    s_cselect_b32 s93, 0, s93
    buffer_load_dwordx4 v[8:11], v248, s[44:47], s92 offen
    buffer_load_dwordx4 v[12:15], v249, s[44:47], s92 offen
    s_add_u32 s92, s92, 1024
    s_cmp_eq_u32 s92, 22528
    s_cselect_b32 s92, 0, s92
    s_waitcnt vmcnt(18)
    s_waitcnt lgkmcnt(0)
    v_mfma_f32_32x32x16_bf16 v[160:175], v[16:19], v[224:227], v[160:175]
    ds_read_b128 v[232:235], v253 offset:6144
    v_mfma_f32_32x32x16_bf16 v[176:191], v[16:19], v[228:231], v[176:191]
    ds_read_b128 v[236:239], v253 offset:7168
    v_mfma_f32_32x32x16_bf16 v[192:207], v[20:23], v[224:227], v[192:207]
    v_mfma_f32_32x32x16_bf16 v[208:223], v[20:23], v[228:231], v[208:223]
    s_add_u32 m0, s89, 4096
    s_nop 0
    buffer_load_dwordx4 v252, s[76:79], s93 offen lds
    s_add_u32 m0, s89, 5120
    s_nop 0
    buffer_load_dwordx4 v252, s[80:83], s93 offen lds
    s_add_u32 s93, s93, 1024
    s_cmp_eq_u32 s93, 22528
    s_cselect_b32 s93, 0, s93
    s_waitcnt vmcnt(18)
    s_waitcnt lgkmcnt(0)
    v_mfma_f32_32x32x16_bf16 v[160:175], v[24:27], v[232:235], v[160:175]
    ds_read_b128 v[224:227], v253 offset:8192
    v_mfma_f32_32x32x16_bf16 v[176:191], v[24:27], v[236:239], v[176:191]
    ds_read_b128 v[228:231], v253 offset:9216
    v_mfma_f32_32x32x16_bf16 v[192:207], v[28:31], v[232:235], v[192:207]
    v_mfma_f32_32x32x16_bf16 v[208:223], v[28:31], v[236:239], v[208:223]
    s_add_u32 m0, s89, 6144
    s_nop 0
    buffer_load_dwordx4 v252, s[76:79], s93 offen lds
    s_add_u32 m0, s89, 7168
    s_nop 0
    buffer_load_dwordx4 v252, s[80:83], s93 offen lds
    s_add_u32 s93, s93, 1024
    s_cmp_eq_u32 s93, 22528
    s_cselect_b32 s93, 0, s93
    s_waitcnt vmcnt(18)
    s_waitcnt lgkmcnt(0)
    v_mfma_f32_32x32x16_bf16 v[160:175], v[32:35], v[224:227], v[160:175]
    ds_read_b128 v[232:235], v253 offset:10240
    v_mfma_f32_32x32x16_bf16 v[176:191], v[32:35], v[228:231], v[176:191]
    ds_read_b128 v[236:239], v253 offset:11264
    v_mfma_f32_32x32x16_bf16 v[192:207], v[36:39], v[224:227], v[192:207]
    v_mfma_f32_32x32x16_bf16 v[208:223], v[36:39], v[228:231], v[208:223]
    s_add_u32 m0, s89, 8192
    s_nop 0
    buffer_load_dwordx4 v252, s[76:79], s93 offen lds
    s_add_u32 m0, s89, 9216
    s_nop 0
    buffer_load_dwordx4 v252, s[80:83], s93 offen lds
    s_add_u32 s93, s93, 1024
    s_cmp_eq_u32 s93, 22528
    s_cselect_b32 s93, 0, s93
    s_waitcnt vmcnt(18)
    s_waitcnt lgkmcnt(0)
    v_mfma_f32_32x32x16_bf16 v[160:175], v[40:43], v[232:235], v[160:175]
    ds_read_b128 v[224:227], v253 offset:12288
    v_mfma_f32_32x32x16_bf16 v[176:191], v[40:43], v[236:239], v[176:191]
    ds_read_b128 v[228:231], v253 offset:13312
    v_mfma_f32_32x32x16_bf16 v[192:207], v[44:47], v[232:235], v[192:207]
    v_mfma_f32_32x32x16_bf16 v[208:223], v[44:47], v[236:239], v[208:223]
    s_add_u32 m0, s89, 10240
    s_nop 0
    buffer_load_dwordx4 v252, s[76:79], s93 offen lds
    s_add_u32 m0, s89, 11264
    s_nop 0
    buffer_load_dwordx4 v252, s[80:83], s93 offen lds
    s_add_u32 s93, s93, 1024
    s_cmp_eq_u32 s93, 22528
    s_cselect_b32 s93, 0, s93
    s_waitcnt vmcnt(18)
    s_waitcnt lgkmcnt(0)
    v_mfma_f32_32x32x16_bf16 v[160:175], v[48:51], v[224:227], v[160:175]
    ds_read_b128 v[232:235], v253 offset:14336
    v_mfma_f32_32x32x16_bf16 v[176:191], v[48:51], v[228:231], v[176:191]
    ds_read_b128 v[236:239], v253 offset:15360
    v_mfma_f32_32x32x16_bf16 v[192:207], v[52:55], v[224:227], v[192:207]
    v_mfma_f32_32x32x16_bf16 v[208:223], v[52:55], v[228:231], v[208:223]
    s_add_u32 m0, s89, 12288
    s_nop 0
    buffer_load_dwordx4 v252, s[76:79], s93 offen lds
    s_add_u32 m0, s89, 13312
    s_nop 0
    buffer_load_dwordx4 v252, s[80:83], s93 offen lds
    s_add_u32 s93, s93, 1024
    s_cmp_eq_u32 s93, 22528
    s_cselect_b32 s93, 0, s93
    s_waitcnt vmcnt(16)
    s_waitcnt lgkmcnt(0)
    v_mfma_f32_32x32x16_bf16 v[160:175], v[56:59], v[232:235], v[160:175]
    ds_read_b128 v[224:227], v253 offset:0
    v_mfma_f32_32x32x16_bf16 v[176:191], v[56:59], v[236:239], v[176:191]
    ds_read_b128 v[228:231], v253 offset:1024
    v_mfma_f32_32x32x16_bf16 v[192:207], v[60:63], v[232:235], v[192:207]
    v_mfma_f32_32x32x16_bf16 v[208:223], v[60:63], v[236:239], v[208:223]
    s_add_u32 m0, s89, 14336
    s_nop 0
    buffer_load_dwordx4 v252, s[76:79], s93 offen lds
    s_add_u32 m0, s89, 15360
    s_nop 0
    buffer_load_dwordx4 v252, s[80:83], s93 offen lds
    s_add_u32 s93, s93, 1024
    s_cmp_eq_u32 s93, 22528
    s_cselect_b32 s93, 0, s93
    s_waitcnt vmcnt(14)
    s_waitcnt lgkmcnt(0)
    v_mfma_f32_32x32x16_bf16 v[160:175], v[64:67], v[224:227], v[160:175]
    ds_read_b128 v[232:235], v253 offset:2048
    v_mfma_f32_32x32x16_bf16 v[176:191], v[64:67], v[228:231], v[176:191]
    ds_read_b128 v[236:239], v253 offset:3072
    v_mfma_f32_32x32x16_bf16 v[192:207], v[68:71], v[224:227], v[192:207]
    v_mfma_f32_32x32x16_bf16 v[208:223], v[68:71], v[228:231], v[208:223]
    s_add_u32 m0, s89, 0
    s_nop 0
    buffer_load_dwordx4 v252, s[76:79], s93 offen lds
    s_add_u32 m0, s89, 1024
    s_nop 0
    buffer_load_dwordx4 v252, s[80:83], s93 offen lds
    s_add_u32 s93, s93, 1024
    s_cmp_eq_u32 s93, 22528
    s_cselect_b32 s93, 0, s93
    s_waitcnt vmcnt(12)
    s_waitcnt lgkmcnt(0)
    v_mfma_f32_32x32x16_bf16 v[160:175], v[72:75], v[232:235], v[160:175]
    ds_read_b128 v[224:227], v253 offset:4096
    v_mfma_f32_32x32x16_bf16 v[176:191], v[72:75], v[236:239], v[176:191]
    ds_read_b128 v[228:231], v253 offset:5120
    v_mfma_f32_32x32x16_bf16 v[192:207], v[76:79], v[232:235], v[192:207]
    v_mfma_f32_32x32x16_bf16 v[208:223], v[76:79], v[236:239], v[208:223]
    s_add_u32 m0, s89, 2048
    s_nop 0
    buffer_load_dwordx4 v252, s[76:79], s93 offen lds
    s_add_u32 m0, s89, 3072
    s_nop 0
    buffer_load_dwordx4 v252, s[80:83], s93 offen lds
    s_add_u32 s93, s93, 1024
    s_cmp_eq_u32 s93, 22528
    s_cselect_b32 s93, 0, s93
    s_waitcnt vmcnt(12)
    s_waitcnt lgkmcnt(0)
    v_mfma_f32_32x32x16_bf16 v[160:175], v[80:83], v[224:227], v[160:175]
    ds_read_b128 v[232:235], v253 offset:6144
    v_mfma_f32_32x32x16_bf16 v[176:191], v[80:83], v[228:231], v[176:191]
    ds_read_b128 v[236:239], v253 offset:7168
    v_mfma_f32_32x32x16_bf16 v[192:207], v[84:87], v[224:227], v[192:207]
    v_mfma_f32_32x32x16_bf16 v[208:223], v[84:87], v[228:231], v[208:223]
    s_add_u32 m0, s89, 4096
    s_nop 0
    buffer_load_dwordx4 v252, s[76:79], s93 offen lds
    s_add_u32 m0, s89, 5120
    s_nop 0
    buffer_load_dwordx4 v252, s[80:83], s93 offen lds
    s_add_u32 s93, s93, 1024
    s_cmp_eq_u32 s93, 22528
    s_cselect_b32 s93, 0, s93
    s_waitcnt vmcnt(12)
    s_waitcnt lgkmcnt(0)
    v_mfma_f32_32x32x16_bf16 v[160:175], v[88:91], v[232:235], v[160:175]
    ds_read_b128 v[224:227], v253 offset:8192
    v_mfma_f32_32x32x16_bf16 v[176:191], v[88:91], v[236:239], v[176:191]
    ds_read_b128 v[228:231], v253 offset:9216
    v_mfma_f32_32x32x16_bf16 v[192:207], v[92:95], v[232:235], v[192:207]
    v_mfma_f32_32x32x16_bf16 v[208:223], v[92:95], v[236:239], v[208:223]
    s_add_u32 m0, s89, 6144
    s_nop 0
    buffer_load_dwordx4 v252, s[76:79], s93 offen lds
    s_add_u32 m0, s89, 7168
    s_nop 0
    buffer_load_dwordx4 v252, s[80:83], s93 offen lds
    s_add_u32 s93, s93, 1024
    s_cmp_eq_u32 s93, 22528
    s_cselect_b32 s93, 0, s93
    s_waitcnt vmcnt(12)
    s_waitcnt lgkmcnt(0)
    v_mfma_f32_32x32x16_bf16 v[160:175], v[96:99], v[224:227], v[160:175]
    ds_read_b128 v[232:235], v253 offset:10240
    v_mfma_f32_32x32x16_bf16 v[176:191], v[96:99], v[228:231], v[176:191]
    ds_read_b128 v[236:239], v253 offset:11264
    v_mfma_f32_32x32x16_bf16 v[192:207], v[100:103], v[224:227], v[192:207]
    v_mfma_f32_32x32x16_bf16 v[208:223], v[100:103], v[228:231], v[208:223]
    s_add_u32 m0, s89, 8192
    s_nop 0
    buffer_load_dwordx4 v252, s[76:79], s93 offen lds
    s_add_u32 m0, s89, 9216
    s_nop 0
    buffer_load_dwordx4 v252, s[80:83], s93 offen lds
    s_add_u32 s93, s93, 1024
    s_cmp_eq_u32 s93, 22528
    s_cselect_b32 s93, 0, s93
    s_waitcnt vmcnt(12)
    s_waitcnt lgkmcnt(0)
    v_mfma_f32_32x32x16_bf16 v[160:175], v[104:107], v[232:235], v[160:175]
    ds_read_b128 v[224:227], v253 offset:12288
    v_mfma_f32_32x32x16_bf16 v[176:191], v[104:107], v[236:239], v[176:191]
    ds_read_b128 v[228:231], v253 offset:13312
    v_mfma_f32_32x32x16_bf16 v[192:207], v[108:111], v[232:235], v[192:207]
    v_mfma_f32_32x32x16_bf16 v[208:223], v[108:111], v[236:239], v[208:223]
    s_add_u32 m0, s89, 10240
    s_nop 0
    buffer_load_dwordx4 v252, s[76:79], s93 offen lds
    s_add_u32 m0, s89, 11264
    s_nop 0
    buffer_load_dwordx4 v252, s[80:83], s93 offen lds
    s_add_u32 s93, s93, 1024
    s_cmp_eq_u32 s93, 22528
    s_cselect_b32 s93, 0, s93
    s_waitcnt vmcnt(12)
    s_waitcnt lgkmcnt(0)
    v_mfma_f32_32x32x16_bf16 v[160:175], v[112:115], v[224:227], v[160:175]
    ds_read_b128 v[232:235], v253 offset:14336
    v_mfma_f32_32x32x16_bf16 v[176:191], v[112:115], v[228:231], v[176:191]
    ds_read_b128 v[236:239], v253 offset:15360
    v_mfma_f32_32x32x16_bf16 v[192:207], v[116:119], v[224:227], v[192:207]
    v_mfma_f32_32x32x16_bf16 v[208:223], v[116:119], v[228:231], v[208:223]
    s_waitcnt vmcnt(10)
    s_waitcnt lgkmcnt(0)
    v_mfma_f32_32x32x16_bf16 v[160:175], v[120:123], v[232:235], v[160:175]
    ds_read_b128 v[224:227], v253 offset:0
    v_mfma_f32_32x32x16_bf16 v[176:191], v[120:123], v[236:239], v[176:191]
    ds_read_b128 v[228:231], v253 offset:1024
    v_mfma_f32_32x32x16_bf16 v[192:207], v[124:127], v[232:235], v[192:207]
    v_mfma_f32_32x32x16_bf16 v[208:223], v[124:127], v[236:239], v[208:223]
    s_waitcnt vmcnt(8)
    s_waitcnt lgkmcnt(0)
    v_mfma_f32_32x32x16_bf16 v[160:175], v[128:131], v[224:227], v[160:175]
    ds_read_b128 v[232:235], v253 offset:2048
    v_mfma_f32_32x32x16_bf16 v[176:191], v[128:131], v[228:231], v[176:191]
    ds_read_b128 v[236:239], v253 offset:3072
    v_mfma_f32_32x32x16_bf16 v[192:207], v[132:135], v[224:227], v[192:207]
    v_mfma_f32_32x32x16_bf16 v[208:223], v[132:135], v[228:231], v[208:223]
    s_waitcnt vmcnt(6)
    s_waitcnt lgkmcnt(0)
    v_mfma_f32_32x32x16_bf16 v[160:175], v[136:139], v[232:235], v[160:175]
    ds_read_b128 v[224:227], v253 offset:4096
    v_mfma_f32_32x32x16_bf16 v[176:191], v[136:139], v[236:239], v[176:191]
    ds_read_b128 v[228:231], v253 offset:5120
    v_mfma_f32_32x32x16_bf16 v[192:207], v[140:143], v[232:235], v[192:207]
    v_mfma_f32_32x32x16_bf16 v[208:223], v[140:143], v[236:239], v[208:223]
    s_waitcnt vmcnt(4)
    s_waitcnt lgkmcnt(0)
    v_mfma_f32_32x32x16_bf16 v[160:175], v[144:147], v[224:227], v[160:175]
    ds_read_b128 v[232:235], v253 offset:6144
    v_mfma_f32_32x32x16_bf16 v[176:191], v[144:147], v[228:231], v[176:191]
    ds_read_b128 v[236:239], v253 offset:7168
    v_mfma_f32_32x32x16_bf16 v[192:207], v[148:151], v[224:227], v[192:207]
    v_mfma_f32_32x32x16_bf16 v[208:223], v[148:151], v[228:231], v[208:223]
    s_waitcnt vmcnt(2)
    s_waitcnt lgkmcnt(0)
    v_mfma_f32_32x32x16_bf16 v[160:175], v[152:155], v[232:235], v[160:175]
    ds_read_b128 v[224:227], v253 offset:8192
    v_mfma_f32_32x32x16_bf16 v[176:191], v[152:155], v[236:239], v[176:191]
    ds_read_b128 v[228:231], v253 offset:9216
    v_mfma_f32_32x32x16_bf16 v[192:207], v[156:159], v[232:235], v[192:207]
    v_mfma_f32_32x32x16_bf16 v[208:223], v[156:159], v[236:239], v[208:223]
    s_waitcnt vmcnt(0)
    s_waitcnt lgkmcnt(0)
    v_mfma_f32_32x32x16_bf16 v[160:175], v[0:3], v[224:227], v[160:175]
    ds_read_b128 v[232:235], v253 offset:10240
    v_mfma_f32_32x32x16_bf16 v[176:191], v[0:3], v[228:231], v[176:191]
    ds_read_b128 v[236:239], v253 offset:11264
    v_mfma_f32_32x32x16_bf16 v[192:207], v[4:7], v[224:227], v[192:207]
    v_mfma_f32_32x32x16_bf16 v[208:223], v[4:7], v[228:231], v[208:223]
    s_waitcnt lgkmcnt(0)
    v_mfma_f32_32x32x16_bf16 v[160:175], v[8:11], v[232:235], v[160:175]
    v_mfma_f32_32x32x16_bf16 v[176:191], v[8:11], v[236:239], v[176:191]
    v_mfma_f32_32x32x16_bf16 v[192:207], v[12:15], v[232:235], v[192:207]
    v_mfma_f32_32x32x16_bf16 v[208:223], v[12:15], v[236:239], v[208:223]
    s_waitcnt vmcnt(0)
    v_sub_f32 v240, 1.0, v240
    v_cvt_pk_bf16_f32 v240, v240, v240
    v_lshlrev_b32 v240, 16, v240
    v_sub_f32 v241, 1.0, v241
    v_cvt_pk_bf16_f32 v241, v241, v241
    v_lshlrev_b32 v241, 16, v241
    s_mov_b32 s90, s89
    s_branch .Lreduce
.Lcompute:
    v_mov_b32 v254, v0
    s_lshr_b32 s78, s3, 1
    s_and_b32 s79, s3, 1
    v_and_b32 v248, 31, v254
    v_lshrrev_b32 v249, 5, v254
    v_bfe_u32 v250, v254, 1, 3
    s_lshl_b32 s72, s3, 12
    s_xor_b32 s73, s72, 4096
    v_add_u32 v251, 0, v249
    v_xor_b32 v251, v251, v250
    v_lshlrev_b32 v251, 4, v251
    v_lshl_add_u32 v251, v248, 7, v251
    v_add_u32 v228, s72, v251
    v_add_u32 v232, s73, v251
    v_add_u32 v251, 2, v249
    v_xor_b32 v251, v251, v250
    v_lshlrev_b32 v251, 4, v251
    v_lshl_add_u32 v251, v248, 7, v251
    v_add_u32 v229, s72, v251
    v_add_u32 v233, s73, v251
    v_add_u32 v251, 4, v249
    v_xor_b32 v251, v251, v250
    v_lshlrev_b32 v251, 4, v251
    v_lshl_add_u32 v251, v248, 7, v251
    v_add_u32 v230, s72, v251
    v_add_u32 v234, s73, v251
    v_add_u32 v251, 6, v249
    v_xor_b32 v251, v251, v250
    v_lshlrev_b32 v251, 4, v251
    v_lshl_add_u32 v251, v248, 7, v251
    v_add_u32 v231, s72, v251
    v_add_u32 v235, s73, v251
    v_lshlrev_b32 v240, 9, v249
    v_bfe_u32 v251, v254, 2, 2
    v_lshl_add_u32 v240, v251, 6, v240
    v_bfe_u32 v251, v254, 4, 1
    v_lshl_add_u32 v240, v251, 5, v240
    v_and_b32 v251, 3, v254
    v_lshl_add_u32 v240, v251, 3, v240
    v_add_u32 v241, 0x10000, v240
    v_add_u32 v242, 0x20000, v240
    s_lshl_b32 s72, s79, 13
    v_add_u32 v243, s72, v241
    v_lshlrev_b32 v247, 4, v254
    s_waitcnt lgkmcnt(0)
    s_mov_b32 s44, s34
    s_mov_b32 s45, s35
    s_mov_b32 s46, 23068672
    s_mov_b32 s47, 0x00020000
    s_mov_b32 s60, s30
    s_mov_b32 s61, s31
    s_mov_b32 s62, 2097152
    s_mov_b32 s63, 0x00020000
    s_mov_b32 s64, s32
    s_mov_b32 s65, s33
    s_mov_b32 s66, 256
    s_mov_b32 s67, 0x00020000
    s_mov_b32 s68, s28
    s_mov_b32 s69, s29
    s_mov_b32 s70, 1024
    s_mov_b32 s71, 0x00020000
    s_or_b32 s72, s2, s3
    s_cmp_lg_u32 s72, 0
    s_cbranch_scc1 .Lnononce
    s_memrealtime s[72:73]
    s_waitcnt lgkmcnt(0)
    s_or_b32 s72, s72, 1
    v_mov_b32 v248, 0
    v_mov_b32 v249, s72
    s_mov_b64 exec, 1
    buffer_store_dword v249, v248, s[64:67], 0 offen sc1
    s_mov_b64 exec, -1
    s_mov_b32 s72, 0
    s_mov_b32 s73, 0
.Lnononce:
    s_cmp_lg_u32 s3, 1
    s_cbranch_scc1 .Lnocpf
    s_cmp_ge_u32 s5, 26
    s_cbranch_scc1 .Lnocpf
    s_getpc_b64 s[72:73]
.Lpcref:
    s_sub_u32 s72, s72, .Lpcref-gated_mix__sliding_block__dense_activation_relu__prompt_kernel
    s_subb_u32 s73, s73, 0
    s_lshl_b32 s74, s5, 10
    v_add_u32 v248, s74, v247
    global_load_dwordx4 v[236:239], v248, s[72:73]
.Lnocpf:
    s_lshl_b32 s76, s96, 1
    s_add_u32 s76, s76, s79
    s_lshl_b32 s76, s76, 5
    s_lshl_b32 s72, s6, 1
    s_add_u32 s72, s72, s78
    s_add_u32 s76, s76, s72
    s_lshl_b32 s76, s76, 2
    s_add_u32 s76, s76, s97
    s_lshl_b32 s76, s76, 2
    s_add_u32 s76, s76, 16842752
    s_cmp_eq_u32 s97, 2
    s_cbranch_scc1 .LstageAV
    s_barrier
    ds_read_b128 v[0:3], v228 offset:0
    ds_read_b128 v[216:219], v232 offset:0
    ds_read_b64_tr_b16 v[192:193], v243 offset:0
    ds_read_b64_tr_b16 v[194:195], v243 offset:256
    ds_read_b64_tr_b16 v[196:197], v243 offset:4096
    ds_read_b64_tr_b16 v[198:199], v243 offset:4352
    ds_read_b128 v[4:7], v229 offset:0
    ds_read_b128 v[220:223], v233 offset:0
    ds_read_b64_tr_b16 v[200:201], v243 offset:1024
    ds_read_b64_tr_b16 v[202:203], v243 offset:1280
    ds_read_b64_tr_b16 v[204:205], v243 offset:5120
    ds_read_b64_tr_b16 v[206:207], v243 offset:5376
    s_waitcnt lgkmcnt(6)
    v_mfma_f32_32x32x16_bf16 v[128:143], v[192:195], v[0:3], 0
    ds_read_b128 v[8:11], v230 offset:0
    ds_read_b128 v[224:227], v234 offset:0
    v_mfma_f32_32x32x16_bf16 v[144:159], v[192:195], v[216:219], 0
    ds_read_b64_tr_b16 v[208:209], v243 offset:2048
    ds_read_b64_tr_b16 v[210:211], v243 offset:2304
    v_mfma_f32_32x32x16_bf16 v[160:175], v[196:199], v[0:3], 0
    ds_read_b64_tr_b16 v[212:213], v243 offset:6144
    ds_read_b64_tr_b16 v[214:215], v243 offset:6400
    v_mfma_f32_32x32x16_bf16 v[176:191], v[196:199], v[216:219], 0
    s_waitcnt lgkmcnt(6)
    v_mfma_f32_32x32x16_bf16 v[128:143], v[200:203], v[4:7], v[128:143]
    ds_read_b128 v[12:15], v231 offset:0
    ds_read_b128 v[216:219], v235 offset:0
    v_mfma_f32_32x32x16_bf16 v[144:159], v[200:203], v[220:223], v[144:159]
    ds_read_b64_tr_b16 v[192:193], v243 offset:3072
    ds_read_b64_tr_b16 v[194:195], v243 offset:3328
    v_mfma_f32_32x32x16_bf16 v[160:175], v[204:207], v[4:7], v[160:175]
    ds_read_b64_tr_b16 v[196:197], v243 offset:7168
    ds_read_b64_tr_b16 v[198:199], v243 offset:7424
    v_mfma_f32_32x32x16_bf16 v[176:191], v[204:207], v[220:223], v[176:191]
    s_waitcnt lgkmcnt(6)
    v_mfma_f32_32x32x16_bf16 v[128:143], v[208:211], v[8:11], v[128:143]
    v_mfma_f32_32x32x16_bf16 v[144:159], v[208:211], v[224:227], v[144:159]
    v_mfma_f32_32x32x16_bf16 v[160:175], v[212:215], v[8:11], v[160:175]
    v_mfma_f32_32x32x16_bf16 v[176:191], v[212:215], v[224:227], v[176:191]
    s_waitcnt lgkmcnt(0)
    s_barrier
    v_mfma_f32_32x32x16_bf16 v[128:143], v[192:195], v[12:15], v[128:143]
    ds_read_b128 v[16:19], v228 offset:16384
    ds_read_b128 v[220:223], v232 offset:16384
    ds_read_b64_tr_b16 v[200:201], v243 offset:16384
    v_mfma_f32_32x32x16_bf16 v[144:159], v[192:195], v[216:219], v[144:159]
    ds_read_b64_tr_b16 v[202:203], v243 offset:16640
    ds_read_b64_tr_b16 v[204:205], v243 offset:20480
    ds_read_b64_tr_b16 v[206:207], v243 offset:20736
    v_mfma_f32_32x32x16_bf16 v[160:175], v[196:199], v[12:15], v[160:175]
    ds_read_b128 v[20:23], v229 offset:16384
    ds_read_b128 v[224:227], v233 offset:16384
    ds_read_b64_tr_b16 v[208:209], v243 offset:17408
    v_mfma_f32_32x32x16_bf16 v[176:191], v[196:199], v[216:219], v[176:191]
    ds_read_b64_tr_b16 v[210:211], v243 offset:17664
    ds_read_b64_tr_b16 v[212:213], v243 offset:21504
    ds_read_b64_tr_b16 v[214:215], v243 offset:21760
    s_waitcnt lgkmcnt(6)
    v_mfma_f32_32x32x16_bf16 v[128:143], v[200:203], v[16:19], v[128:143]
    ds_read_b128 v[24:27], v230 offset:16384
    ds_read_b128 v[216:219], v234 offset:16384
    v_mfma_f32_32x32x16_bf16 v[144:159], v[200:203], v[220:223], v[144:159]
    ds_read_b64_tr_b16 v[192:193], v243 offset:18432
    ds_read_b64_tr_b16 v[194:195], v243 offset:18688
    v_mfma_f32_32x32x16_bf16 v[160:175], v[204:207], v[16:19], v[160:175]
    ds_read_b64_tr_b16 v[196:197], v243 offset:22528
    ds_read_b64_tr_b16 v[198:199], v243 offset:22784
    v_mfma_f32_32x32x16_bf16 v[176:191], v[204:207], v[220:223], v[176:191]
    s_waitcnt lgkmcnt(6)
    v_mfma_f32_32x32x16_bf16 v[128:143], v[208:211], v[20:23], v[128:143]
    ds_read_b128 v[28:31], v231 offset:16384
    ds_read_b128 v[220:223], v235 offset:16384
    v_mfma_f32_32x32x16_bf16 v[144:159], v[208:211], v[224:227], v[144:159]
    ds_read_b64_tr_b16 v[200:201], v243 offset:19456
    ds_read_b64_tr_b16 v[202:203], v243 offset:19712
    v_mfma_f32_32x32x16_bf16 v[160:175], v[212:215], v[20:23], v[160:175]
    ds_read_b64_tr_b16 v[204:205], v243 offset:23552
    ds_read_b64_tr_b16 v[206:207], v243 offset:23808
    v_mfma_f32_32x32x16_bf16 v[176:191], v[212:215], v[224:227], v[176:191]
    s_waitcnt lgkmcnt(6)
    v_mfma_f32_32x32x16_bf16 v[128:143], v[192:195], v[24:27], v[128:143]
    v_mfma_f32_32x32x16_bf16 v[144:159], v[192:195], v[216:219], v[144:159]
    v_mfma_f32_32x32x16_bf16 v[160:175], v[196:199], v[24:27], v[160:175]
    v_mfma_f32_32x32x16_bf16 v[176:191], v[196:199], v[216:219], v[176:191]
    s_waitcnt lgkmcnt(0)
    s_barrier
    v_mfma_f32_32x32x16_bf16 v[128:143], v[200:203], v[28:31], v[128:143]
    ds_read_b128 v[32:35], v228 offset:32768
    ds_read_b128 v[224:227], v232 offset:32768
    ds_read_b64_tr_b16 v[208:209], v243 offset:32768
    v_mfma_f32_32x32x16_bf16 v[144:159], v[200:203], v[220:223], v[144:159]
    ds_read_b64_tr_b16 v[210:211], v243 offset:33024
    ds_read_b64_tr_b16 v[212:213], v243 offset:36864
    ds_read_b64_tr_b16 v[214:215], v243 offset:37120
    v_mfma_f32_32x32x16_bf16 v[160:175], v[204:207], v[28:31], v[160:175]
    ds_read_b128 v[36:39], v229 offset:32768
    ds_read_b128 v[216:219], v233 offset:32768
    ds_read_b64_tr_b16 v[192:193], v243 offset:33792
    v_mfma_f32_32x32x16_bf16 v[176:191], v[204:207], v[220:223], v[176:191]
    ds_read_b64_tr_b16 v[194:195], v243 offset:34048
    ds_read_b64_tr_b16 v[196:197], v243 offset:37888
    ds_read_b64_tr_b16 v[198:199], v243 offset:38144
    s_waitcnt lgkmcnt(6)
    v_mfma_f32_32x32x16_bf16 v[128:143], v[208:211], v[32:35], v[128:143]
    ds_read_b128 v[40:43], v230 offset:32768
    ds_read_b128 v[220:223], v234 offset:32768
    v_mfma_f32_32x32x16_bf16 v[144:159], v[208:211], v[224:227], v[144:159]
    ds_read_b64_tr_b16 v[200:201], v243 offset:34816
    ds_read_b64_tr_b16 v[202:203], v243 offset:35072
    v_mfma_f32_32x32x16_bf16 v[160:175], v[212:215], v[32:35], v[160:175]
    ds_read_b64_tr_b16 v[204:205], v243 offset:38912
    ds_read_b64_tr_b16 v[206:207], v243 offset:39168
    v_mfma_f32_32x32x16_bf16 v[176:191], v[212:215], v[224:227], v[176:191]
    s_waitcnt lgkmcnt(6)
    v_mfma_f32_32x32x16_bf16 v[128:143], v[192:195], v[36:39], v[128:143]
    ds_read_b128 v[44:47], v231 offset:32768
    ds_read_b128 v[224:227], v235 offset:32768
    v_mfma_f32_32x32x16_bf16 v[144:159], v[192:195], v[216:219], v[144:159]
    ds_read_b64_tr_b16 v[208:209], v243 offset:35840
    ds_read_b64_tr_b16 v[210:211], v243 offset:36096
    v_mfma_f32_32x32x16_bf16 v[160:175], v[196:199], v[36:39], v[160:175]
    ds_read_b64_tr_b16 v[212:213], v243 offset:39936
    ds_read_b64_tr_b16 v[214:215], v243 offset:40192
    v_mfma_f32_32x32x16_bf16 v[176:191], v[196:199], v[216:219], v[176:191]
    s_waitcnt lgkmcnt(6)
    v_mfma_f32_32x32x16_bf16 v[128:143], v[200:203], v[40:43], v[128:143]
    v_mfma_f32_32x32x16_bf16 v[144:159], v[200:203], v[220:223], v[144:159]
    v_mfma_f32_32x32x16_bf16 v[160:175], v[204:207], v[40:43], v[160:175]
    v_mfma_f32_32x32x16_bf16 v[176:191], v[204:207], v[220:223], v[176:191]
    s_waitcnt lgkmcnt(0)
    s_barrier
    v_mfma_f32_32x32x16_bf16 v[128:143], v[208:211], v[44:47], v[128:143]
    ds_read_b128 v[48:51], v228 offset:49152
    ds_read_b128 v[216:219], v232 offset:49152
    ds_read_b64_tr_b16 v[192:193], v243 offset:49152
    v_mfma_f32_32x32x16_bf16 v[144:159], v[208:211], v[224:227], v[144:159]
    ds_read_b64_tr_b16 v[194:195], v243 offset:49408
    ds_read_b64_tr_b16 v[196:197], v243 offset:53248
    ds_read_b64_tr_b16 v[198:199], v243 offset:53504
    v_mfma_f32_32x32x16_bf16 v[160:175], v[212:215], v[44:47], v[160:175]
    ds_read_b128 v[52:55], v229 offset:49152
    ds_read_b128 v[220:223], v233 offset:49152
    ds_read_b64_tr_b16 v[200:201], v243 offset:50176
    v_mfma_f32_32x32x16_bf16 v[176:191], v[212:215], v[224:227], v[176:191]
    ds_read_b64_tr_b16 v[202:203], v243 offset:50432
    ds_read_b64_tr_b16 v[204:205], v243 offset:54272
    ds_read_b64_tr_b16 v[206:207], v243 offset:54528
    s_waitcnt lgkmcnt(6)
    v_mfma_f32_32x32x16_bf16 v[128:143], v[192:195], v[48:51], v[128:143]
    ds_read_b128 v[56:59], v230 offset:49152
    ds_read_b128 v[224:227], v234 offset:49152
    v_mfma_f32_32x32x16_bf16 v[144:159], v[192:195], v[216:219], v[144:159]
    ds_read_b64_tr_b16 v[208:209], v243 offset:51200
    ds_read_b64_tr_b16 v[210:211], v243 offset:51456
    v_mfma_f32_32x32x16_bf16 v[160:175], v[196:199], v[48:51], v[160:175]
    ds_read_b64_tr_b16 v[212:213], v243 offset:55296
    ds_read_b64_tr_b16 v[214:215], v243 offset:55552
    v_mfma_f32_32x32x16_bf16 v[176:191], v[196:199], v[216:219], v[176:191]
    s_waitcnt lgkmcnt(6)
    v_mfma_f32_32x32x16_bf16 v[128:143], v[200:203], v[52:55], v[128:143]
    ds_read_b128 v[60:63], v231 offset:49152
    ds_read_b128 v[216:219], v235 offset:49152
    v_mfma_f32_32x32x16_bf16 v[144:159], v[200:203], v[220:223], v[144:159]
    ds_read_b64_tr_b16 v[192:193], v243 offset:52224
    ds_read_b64_tr_b16 v[194:195], v243 offset:52480
    v_mfma_f32_32x32x16_bf16 v[160:175], v[204:207], v[52:55], v[160:175]
    ds_read_b64_tr_b16 v[196:197], v243 offset:56320
    ds_read_b64_tr_b16 v[198:199], v243 offset:56576
    v_mfma_f32_32x32x16_bf16 v[176:191], v[204:207], v[220:223], v[176:191]
    s_waitcnt lgkmcnt(6)
    v_mfma_f32_32x32x16_bf16 v[128:143], v[208:211], v[56:59], v[128:143]
    v_mfma_f32_32x32x16_bf16 v[144:159], v[208:211], v[224:227], v[144:159]
    v_mfma_f32_32x32x16_bf16 v[160:175], v[212:215], v[56:59], v[160:175]
    v_mfma_f32_32x32x16_bf16 v[176:191], v[212:215], v[224:227], v[176:191]
    s_waitcnt lgkmcnt(0)
    s_barrier
    v_mfma_f32_32x32x16_bf16 v[128:143], v[192:195], v[60:63], v[128:143]
    ds_read_b128 v[64:67], v228 offset:0
    ds_read_b128 v[220:223], v232 offset:0
    ds_read_b64_tr_b16 v[200:201], v243 offset:0
    v_mfma_f32_32x32x16_bf16 v[144:159], v[192:195], v[216:219], v[144:159]
    ds_read_b64_tr_b16 v[202:203], v243 offset:256
    ds_read_b64_tr_b16 v[204:205], v243 offset:4096
    ds_read_b64_tr_b16 v[206:207], v243 offset:4352
    v_mfma_f32_32x32x16_bf16 v[160:175], v[196:199], v[60:63], v[160:175]
    ds_read_b128 v[68:71], v229 offset:0
    ds_read_b128 v[224:227], v233 offset:0
    ds_read_b64_tr_b16 v[208:209], v243 offset:1024
    v_mfma_f32_32x32x16_bf16 v[176:191], v[196:199], v[216:219], v[176:191]
    ds_read_b64_tr_b16 v[210:211], v243 offset:1280
    ds_read_b64_tr_b16 v[212:213], v243 offset:5120
    ds_read_b64_tr_b16 v[214:215], v243 offset:5376
    s_waitcnt lgkmcnt(6)
    v_mfma_f32_32x32x16_bf16 v[128:143], v[200:203], v[64:67], v[128:143]
    ds_read_b128 v[72:75], v230 offset:0
    ds_read_b128 v[216:219], v234 offset:0
    v_mfma_f32_32x32x16_bf16 v[144:159], v[200:203], v[220:223], v[144:159]
    ds_read_b64_tr_b16 v[192:193], v243 offset:2048
    ds_read_b64_tr_b16 v[194:195], v243 offset:2304
    v_mfma_f32_32x32x16_bf16 v[160:175], v[204:207], v[64:67], v[160:175]
    ds_read_b64_tr_b16 v[196:197], v243 offset:6144
    ds_read_b64_tr_b16 v[198:199], v243 offset:6400
    v_mfma_f32_32x32x16_bf16 v[176:191], v[204:207], v[220:223], v[176:191]
    s_waitcnt lgkmcnt(6)
    v_mfma_f32_32x32x16_bf16 v[128:143], v[208:211], v[68:71], v[128:143]
    ds_read_b128 v[76:79], v231 offset:0
    ds_read_b128 v[220:223], v235 offset:0
    v_mfma_f32_32x32x16_bf16 v[144:159], v[208:211], v[224:227], v[144:159]
    ds_read_b64_tr_b16 v[200:201], v243 offset:3072
    ds_read_b64_tr_b16 v[202:203], v243 offset:3328
    v_mfma_f32_32x32x16_bf16 v[160:175], v[212:215], v[68:71], v[160:175]
    ds_read_b64_tr_b16 v[204:205], v243 offset:7168
    ds_read_b64_tr_b16 v[206:207], v243 offset:7424
    v_mfma_f32_32x32x16_bf16 v[176:191], v[212:215], v[224:227], v[176:191]
    s_waitcnt lgkmcnt(6)
    v_mfma_f32_32x32x16_bf16 v[128:143], v[192:195], v[72:75], v[128:143]
    v_mfma_f32_32x32x16_bf16 v[144:159], v[192:195], v[216:219], v[144:159]
    v_mfma_f32_32x32x16_bf16 v[160:175], v[196:199], v[72:75], v[160:175]
    v_mfma_f32_32x32x16_bf16 v[176:191], v[196:199], v[216:219], v[176:191]
    s_waitcnt lgkmcnt(0)
    s_barrier
    v_mfma_f32_32x32x16_bf16 v[128:143], v[200:203], v[76:79], v[128:143]
    ds_read_b128 v[80:83], v228 offset:16384
    ds_read_b128 v[224:227], v232 offset:16384
    ds_read_b64_tr_b16 v[208:209], v243 offset:16384
    v_mfma_f32_32x32x16_bf16 v[144:159], v[200:203], v[220:223], v[144:159]
    ds_read_b64_tr_b16 v[210:211], v243 offset:16640
    ds_read_b64_tr_b16 v[212:213], v243 offset:20480
    ds_read_b64_tr_b16 v[214:215], v243 offset:20736
    v_mfma_f32_32x32x16_bf16 v[160:175], v[204:207], v[76:79], v[160:175]
    ds_read_b128 v[84:87], v229 offset:16384
    ds_read_b128 v[216:219], v233 offset:16384
    ds_read_b64_tr_b16 v[192:193], v243 offset:17408
    v_mfma_f32_32x32x16_bf16 v[176:191], v[204:207], v[220:223], v[176:191]
    ds_read_b64_tr_b16 v[194:195], v243 offset:17664
    ds_read_b64_tr_b16 v[196:197], v243 offset:21504
    ds_read_b64_tr_b16 v[198:199], v243 offset:21760
    s_waitcnt lgkmcnt(6)
    v_mfma_f32_32x32x16_bf16 v[128:143], v[208:211], v[80:83], v[128:143]
    ds_read_b128 v[88:91], v230 offset:16384
    ds_read_b128 v[220:223], v234 offset:16384
    v_mfma_f32_32x32x16_bf16 v[144:159], v[208:211], v[224:227], v[144:159]
    ds_read_b64_tr_b16 v[200:201], v243 offset:18432
    ds_read_b64_tr_b16 v[202:203], v243 offset:18688
    v_mfma_f32_32x32x16_bf16 v[160:175], v[212:215], v[80:83], v[160:175]
    ds_read_b64_tr_b16 v[204:205], v243 offset:22528
    ds_read_b64_tr_b16 v[206:207], v243 offset:22784
    v_mfma_f32_32x32x16_bf16 v[176:191], v[212:215], v[224:227], v[176:191]
    s_waitcnt lgkmcnt(6)
    v_mfma_f32_32x32x16_bf16 v[128:143], v[192:195], v[84:87], v[128:143]
    ds_read_b128 v[92:95], v231 offset:16384
    ds_read_b128 v[224:227], v235 offset:16384
    v_mfma_f32_32x32x16_bf16 v[144:159], v[192:195], v[216:219], v[144:159]
    ds_read_b64_tr_b16 v[208:209], v243 offset:19456
    ds_read_b64_tr_b16 v[210:211], v243 offset:19712
    v_mfma_f32_32x32x16_bf16 v[160:175], v[196:199], v[84:87], v[160:175]
    ds_read_b64_tr_b16 v[212:213], v243 offset:23552
    ds_read_b64_tr_b16 v[214:215], v243 offset:23808
    v_mfma_f32_32x32x16_bf16 v[176:191], v[196:199], v[216:219], v[176:191]
    s_waitcnt lgkmcnt(6)
    v_mfma_f32_32x32x16_bf16 v[128:143], v[200:203], v[88:91], v[128:143]
    v_mfma_f32_32x32x16_bf16 v[144:159], v[200:203], v[220:223], v[144:159]
    v_mfma_f32_32x32x16_bf16 v[160:175], v[204:207], v[88:91], v[160:175]
    v_mfma_f32_32x32x16_bf16 v[176:191], v[204:207], v[220:223], v[176:191]
    s_waitcnt lgkmcnt(0)
    s_barrier
    v_mfma_f32_32x32x16_bf16 v[128:143], v[208:211], v[92:95], v[128:143]
    ds_read_b128 v[96:99], v228 offset:32768
    ds_read_b128 v[216:219], v232 offset:32768
    ds_read_b64_tr_b16 v[192:193], v243 offset:32768
    v_mfma_f32_32x32x16_bf16 v[144:159], v[208:211], v[224:227], v[144:159]
    ds_read_b64_tr_b16 v[194:195], v243 offset:33024
    ds_read_b64_tr_b16 v[196:197], v243 offset:36864
    ds_read_b64_tr_b16 v[198:199], v243 offset:37120
    v_mfma_f32_32x32x16_bf16 v[160:175], v[212:215], v[92:95], v[160:175]
    ds_read_b128 v[100:103], v229 offset:32768
    ds_read_b128 v[220:223], v233 offset:32768
    ds_read_b64_tr_b16 v[200:201], v243 offset:33792
    v_mfma_f32_32x32x16_bf16 v[176:191], v[212:215], v[224:227], v[176:191]
    ds_read_b64_tr_b16 v[202:203], v243 offset:34048
    ds_read_b64_tr_b16 v[204:205], v243 offset:37888
    ds_read_b64_tr_b16 v[206:207], v243 offset:38144
    s_waitcnt lgkmcnt(6)
    v_mfma_f32_32x32x16_bf16 v[128:143], v[192:195], v[96:99], v[128:143]
    ds_read_b128 v[104:107], v230 offset:32768
    ds_read_b128 v[224:227], v234 offset:32768
    v_mfma_f32_32x32x16_bf16 v[144:159], v[192:195], v[216:219], v[144:159]
    ds_read_b64_tr_b16 v[208:209], v243 offset:34816
    ds_read_b64_tr_b16 v[210:211], v243 offset:35072
    v_mfma_f32_32x32x16_bf16 v[160:175], v[196:199], v[96:99], v[160:175]
    ds_read_b64_tr_b16 v[212:213], v243 offset:38912
    ds_read_b64_tr_b16 v[214:215], v243 offset:39168
    v_mfma_f32_32x32x16_bf16 v[176:191], v[196:199], v[216:219], v[176:191]
    s_waitcnt lgkmcnt(6)
    v_mfma_f32_32x32x16_bf16 v[128:143], v[200:203], v[100:103], v[128:143]
    ds_read_b128 v[108:111], v231 offset:32768
    ds_read_b128 v[216:219], v235 offset:32768
    v_mfma_f32_32x32x16_bf16 v[144:159], v[200:203], v[220:223], v[144:159]
    ds_read_b64_tr_b16 v[192:193], v243 offset:35840
    ds_read_b64_tr_b16 v[194:195], v243 offset:36096
    v_mfma_f32_32x32x16_bf16 v[160:175], v[204:207], v[100:103], v[160:175]
    ds_read_b64_tr_b16 v[196:197], v243 offset:39936
    ds_read_b64_tr_b16 v[198:199], v243 offset:40192
    v_mfma_f32_32x32x16_bf16 v[176:191], v[204:207], v[220:223], v[176:191]
    s_waitcnt lgkmcnt(6)
    v_mfma_f32_32x32x16_bf16 v[128:143], v[208:211], v[104:107], v[128:143]
    v_mfma_f32_32x32x16_bf16 v[144:159], v[208:211], v[224:227], v[144:159]
    v_mfma_f32_32x32x16_bf16 v[160:175], v[212:215], v[104:107], v[160:175]
    v_mfma_f32_32x32x16_bf16 v[176:191], v[212:215], v[224:227], v[176:191]
    s_waitcnt lgkmcnt(0)
    s_barrier
    v_mfma_f32_32x32x16_bf16 v[128:143], v[192:195], v[108:111], v[128:143]
    ds_read_b128 v[112:115], v228 offset:49152
    ds_read_b128 v[220:223], v232 offset:49152
    ds_read_b64_tr_b16 v[200:201], v243 offset:49152
    v_mfma_f32_32x32x16_bf16 v[144:159], v[192:195], v[216:219], v[144:159]
    ds_read_b64_tr_b16 v[202:203], v243 offset:49408
    ds_read_b64_tr_b16 v[204:205], v243 offset:53248
    ds_read_b64_tr_b16 v[206:207], v243 offset:53504
    v_mfma_f32_32x32x16_bf16 v[160:175], v[196:199], v[108:111], v[160:175]
    ds_read_b128 v[116:119], v229 offset:49152
    ds_read_b128 v[224:227], v233 offset:49152
    ds_read_b64_tr_b16 v[208:209], v243 offset:50176
    v_mfma_f32_32x32x16_bf16 v[176:191], v[196:199], v[216:219], v[176:191]
    ds_read_b64_tr_b16 v[210:211], v243 offset:50432
    ds_read_b64_tr_b16 v[212:213], v243 offset:54272
    ds_read_b64_tr_b16 v[214:215], v243 offset:54528
    s_waitcnt lgkmcnt(6)
    v_mfma_f32_32x32x16_bf16 v[128:143], v[200:203], v[112:115], v[128:143]
    ds_read_b128 v[120:123], v230 offset:49152
    ds_read_b128 v[216:219], v234 offset:49152
    v_mfma_f32_32x32x16_bf16 v[144:159], v[200:203], v[220:223], v[144:159]
    ds_read_b64_tr_b16 v[192:193], v243 offset:51200
    ds_read_b64_tr_b16 v[194:195], v243 offset:51456
    v_mfma_f32_32x32x16_bf16 v[160:175], v[204:207], v[112:115], v[160:175]
    ds_read_b64_tr_b16 v[196:197], v243 offset:55296
    ds_read_b64_tr_b16 v[198:199], v243 offset:55552
    v_mfma_f32_32x32x16_bf16 v[176:191], v[204:207], v[220:223], v[176:191]
    s_waitcnt lgkmcnt(6)
    v_mfma_f32_32x32x16_bf16 v[128:143], v[208:211], v[116:119], v[128:143]
    ds_read_b128 v[124:127], v231 offset:49152
    ds_read_b128 v[220:223], v235 offset:49152
    v_mfma_f32_32x32x16_bf16 v[144:159], v[208:211], v[224:227], v[144:159]
    ds_read_b64_tr_b16 v[200:201], v243 offset:52224
    ds_read_b64_tr_b16 v[202:203], v243 offset:52480
    v_mfma_f32_32x32x16_bf16 v[160:175], v[212:215], v[116:119], v[160:175]
    ds_read_b64_tr_b16 v[204:205], v243 offset:56320
    ds_read_b64_tr_b16 v[206:207], v243 offset:56576
    v_mfma_f32_32x32x16_bf16 v[176:191], v[212:215], v[224:227], v[176:191]
    s_waitcnt lgkmcnt(6)
    v_mfma_f32_32x32x16_bf16 v[128:143], v[192:195], v[120:123], v[128:143]
    v_mfma_f32_32x32x16_bf16 v[144:159], v[192:195], v[216:219], v[144:159]
    v_mfma_f32_32x32x16_bf16 v[160:175], v[196:199], v[120:123], v[160:175]
    v_mfma_f32_32x32x16_bf16 v[176:191], v[196:199], v[216:219], v[176:191]
    s_waitcnt lgkmcnt(0)
    v_mfma_f32_32x32x16_bf16 v[128:143], v[200:203], v[124:127], v[128:143]
    v_mfma_f32_32x32x16_bf16 v[144:159], v[200:203], v[220:223], v[144:159]
    v_mfma_f32_32x32x16_bf16 v[160:175], v[204:207], v[124:127], v[160:175]
    v_mfma_f32_32x32x16_bf16 v[176:191], v[204:207], v[220:223], v[176:191]
    s_cmp_eq_u32 s97, 3
    s_cbranch_scc1 .LepiH
    s_lshl_b32 s72, s96, 9
    s_lshl_b32 s73, s79, 8
    s_add_u32 s72, s72, s73
    s_add_u32 s72, s72, s93
    s_lshl_b32 s72, s72, 10
    s_lshl_b32 s73, s97, 21
    s_add_u32 s72, s72, s73
    s_xor_b32 s74, s72, 1024
    s_mov_b32 s73, 1052289595
    s_cmp_eq_u32 s97, 0
    s_cselect_b32 s73, s73, 1.0
    v_add_u32 v248, 0x10000, v247
    s_nop 2
    v_mul_f32 v128, s73, v128
    v_mul_f32 v129, s73, v129
    v_mul_f32 v130, s73, v130
    v_mul_f32 v131, s73, v131
    v_mul_f32 v132, s73, v132
    v_mul_f32 v133, s73, v133
    v_mul_f32 v134, s73, v134
    v_mul_f32 v135, s73, v135
    v_mul_f32 v136, s73, v136
    v_mul_f32 v137, s73, v137
    v_mul_f32 v138, s73, v138
    v_mul_f32 v139, s73, v139
    v_mul_f32 v140, s73, v140
    v_mul_f32 v141, s73, v141
    v_mul_f32 v142, s73, v142
    v_mul_f32 v143, s73, v143
    v_cvt_pk_bf16_f32 v128, v128, v129
    v_cvt_pk_bf16_f32 v129, v130, v131
    v_cvt_pk_bf16_f32 v130, v132, v133
    v_cvt_pk_bf16_f32 v131, v134, v135
    v_cvt_pk_bf16_f32 v132, v136, v137
    v_cvt_pk_bf16_f32 v133, v138, v139
    v_cvt_pk_bf16_f32 v134, v140, v141
    v_cvt_pk_bf16_f32 v135, v142, v143
    buffer_store_dwordx4 v[128:131], v247, s[44:47], s72 offen sc1
    buffer_store_dwordx4 v[132:135], v248, s[44:47], s72 offen sc1
    v_mul_f32 v144, s73, v144
    v_mul_f32 v145, s73, v145
    v_mul_f32 v146, s73, v146
    v_mul_f32 v147, s73, v147
    v_mul_f32 v148, s73, v148
    v_mul_f32 v149, s73, v149
    v_mul_f32 v150, s73, v150
    v_mul_f32 v151, s73, v151
    v_mul_f32 v152, s73, v152
    v_mul_f32 v153, s73, v153
    v_mul_f32 v154, s73, v154
    v_mul_f32 v155, s73, v155
    v_mul_f32 v156, s73, v156
    v_mul_f32 v157, s73, v157
    v_mul_f32 v158, s73, v158
    v_mul_f32 v159, s73, v159
    v_cvt_pk_bf16_f32 v144, v144, v145
    v_cvt_pk_bf16_f32 v145, v146, v147
    v_cvt_pk_bf16_f32 v146, v148, v149
    v_cvt_pk_bf16_f32 v147, v150, v151
    v_cvt_pk_bf16_f32 v148, v152, v153
    v_cvt_pk_bf16_f32 v149, v154, v155
    v_cvt_pk_bf16_f32 v150, v156, v157
    v_cvt_pk_bf16_f32 v151, v158, v159
    buffer_store_dwordx4 v[144:147], v247, s[44:47], s74 offen sc1
    buffer_store_dwordx4 v[148:151], v248, s[44:47], s74 offen sc1
    s_add_u32 s72, s72, 0x20000
    s_add_u32 s74, s74, 0x20000
    v_mul_f32 v160, s73, v160
    v_mul_f32 v161, s73, v161
    v_mul_f32 v162, s73, v162
    v_mul_f32 v163, s73, v163
    v_mul_f32 v164, s73, v164
    v_mul_f32 v165, s73, v165
    v_mul_f32 v166, s73, v166
    v_mul_f32 v167, s73, v167
    v_mul_f32 v168, s73, v168
    v_mul_f32 v169, s73, v169
    v_mul_f32 v170, s73, v170
    v_mul_f32 v171, s73, v171
    v_mul_f32 v172, s73, v172
    v_mul_f32 v173, s73, v173
    v_mul_f32 v174, s73, v174
    v_mul_f32 v175, s73, v175
    v_cvt_pk_bf16_f32 v160, v160, v161
    v_cvt_pk_bf16_f32 v161, v162, v163
    v_cvt_pk_bf16_f32 v162, v164, v165
    v_cvt_pk_bf16_f32 v163, v166, v167
    v_cvt_pk_bf16_f32 v164, v168, v169
    v_cvt_pk_bf16_f32 v165, v170, v171
    v_cvt_pk_bf16_f32 v166, v172, v173
    v_cvt_pk_bf16_f32 v167, v174, v175
    buffer_store_dwordx4 v[160:163], v247, s[44:47], s72 offen sc1
    buffer_store_dwordx4 v[164:167], v248, s[44:47], s72 offen sc1
    v_mul_f32 v176, s73, v176
    v_mul_f32 v177, s73, v177
    v_mul_f32 v178, s73, v178
    v_mul_f32 v179, s73, v179
    v_mul_f32 v180, s73, v180
    v_mul_f32 v181, s73, v181
    v_mul_f32 v182, s73, v182
    v_mul_f32 v183, s73, v183
    v_mul_f32 v184, s73, v184
    v_mul_f32 v185, s73, v185
    v_mul_f32 v186, s73, v186
    v_mul_f32 v187, s73, v187
    v_mul_f32 v188, s73, v188
    v_mul_f32 v189, s73, v189
    v_mul_f32 v190, s73, v190
    v_mul_f32 v191, s73, v191
    v_cvt_pk_bf16_f32 v176, v176, v177
    v_cvt_pk_bf16_f32 v177, v178, v179
    v_cvt_pk_bf16_f32 v178, v180, v181
    v_cvt_pk_bf16_f32 v179, v182, v183
    v_cvt_pk_bf16_f32 v180, v184, v185
    v_cvt_pk_bf16_f32 v181, v186, v187
    v_cvt_pk_bf16_f32 v182, v188, v189
    v_cvt_pk_bf16_f32 v183, v190, v191
    buffer_store_dwordx4 v[176:179], v247, s[44:47], s74 offen sc1
    buffer_store_dwordx4 v[180:183], v248, s[44:47], s74 offen sc1
    s_branch .LstageB
.LepiH:
    s_lshl_b32 s73, s79, 1
    s_add_u32 s73, s73, s95
    s_lshl_b32 s73, s73, 1
    s_mul_i32 s72, s93, 118
    s_add_u32 s72, s72, s73
    s_lshl_b32 s72, s72, 10
    s_add_u32 s72, s72, 6291456
    s_xor_b32 s74, s93, 1
    s_mul_i32 s74, s74, 118
    s_add_u32 s74, s74, s73
    s_lshl_b32 s74, s74, 10
    s_add_u32 s74, s74, 6291456
    s_nop 2
    v_cvt_pk_bf16_f32 v128, v128, v129
    v_cvt_pk_bf16_f32 v129, v130, v131
    v_cvt_pk_bf16_f32 v130, v132, v133
    v_cvt_pk_bf16_f32 v131, v134, v135
    v_cvt_pk_bf16_f32 v132, v136, v137
    v_cvt_pk_bf16_f32 v133, v138, v139
    v_cvt_pk_bf16_f32 v134, v140, v141
    v_cvt_pk_bf16_f32 v135, v142, v143
    v_pk_max_i16 v128, v128, 0
    v_pk_max_i16 v129, v129, 0
    v_pk_max_i16 v130, v130, 0
    v_pk_max_i16 v131, v131, 0
    v_pk_max_i16 v132, v132, 0
    v_pk_max_i16 v133, v133, 0
    v_pk_max_i16 v134, v134, 0
    v_pk_max_i16 v135, v135, 0
    buffer_store_dwordx4 v[128:131], v247, s[44:47], s72 offen offset:0 sc1
    buffer_store_dwordx4 v[132:135], v247, s[44:47], s72 offen offset:1024 sc1
    v_cvt_pk_bf16_f32 v144, v144, v145
    v_cvt_pk_bf16_f32 v145, v146, v147
    v_cvt_pk_bf16_f32 v146, v148, v149
    v_cvt_pk_bf16_f32 v147, v150, v151
    v_cvt_pk_bf16_f32 v148, v152, v153
    v_cvt_pk_bf16_f32 v149, v154, v155
    v_cvt_pk_bf16_f32 v150, v156, v157
    v_cvt_pk_bf16_f32 v151, v158, v159
    v_pk_max_i16 v144, v144, 0
    v_pk_max_i16 v145, v145, 0
    v_pk_max_i16 v146, v146, 0
    v_pk_max_i16 v147, v147, 0
    v_pk_max_i16 v148, v148, 0
    v_pk_max_i16 v149, v149, 0
    v_pk_max_i16 v150, v150, 0
    v_pk_max_i16 v151, v151, 0
    buffer_store_dwordx4 v[144:147], v247, s[44:47], s74 offen offset:0 sc1
    buffer_store_dwordx4 v[148:151], v247, s[44:47], s74 offen offset:1024 sc1
    v_cvt_pk_bf16_f32 v160, v160, v161
    v_cvt_pk_bf16_f32 v161, v162, v163
    v_cvt_pk_bf16_f32 v162, v164, v165
    v_cvt_pk_bf16_f32 v163, v166, v167
    v_cvt_pk_bf16_f32 v164, v168, v169
    v_cvt_pk_bf16_f32 v165, v170, v171
    v_cvt_pk_bf16_f32 v166, v172, v173
    v_cvt_pk_bf16_f32 v167, v174, v175
    v_pk_max_i16 v160, v160, 0
    v_pk_max_i16 v161, v161, 0
    v_pk_max_i16 v162, v162, 0
    v_pk_max_i16 v163, v163, 0
    v_pk_max_i16 v164, v164, 0
    v_pk_max_i16 v165, v165, 0
    v_pk_max_i16 v166, v166, 0
    v_pk_max_i16 v167, v167, 0
    buffer_store_dwordx4 v[160:163], v247, s[44:47], s72 offen offset:2048 sc1
    buffer_store_dwordx4 v[164:167], v247, s[44:47], s72 offen offset:3072 sc1
    v_cvt_pk_bf16_f32 v176, v176, v177
    v_cvt_pk_bf16_f32 v177, v178, v179
    v_cvt_pk_bf16_f32 v178, v180, v181
    v_cvt_pk_bf16_f32 v179, v182, v183
    v_cvt_pk_bf16_f32 v180, v184, v185
    v_cvt_pk_bf16_f32 v181, v186, v187
    v_cvt_pk_bf16_f32 v182, v188, v189
    v_cvt_pk_bf16_f32 v183, v190, v191
    v_pk_max_i16 v176, v176, 0
    v_pk_max_i16 v177, v177, 0
    v_pk_max_i16 v178, v178, 0
    v_pk_max_i16 v179, v179, 0
    v_pk_max_i16 v180, v180, 0
    v_pk_max_i16 v181, v181, 0
    v_pk_max_i16 v182, v182, 0
    v_pk_max_i16 v183, v183, 0
    buffer_store_dwordx4 v[176:179], v247, s[44:47], s74 offen offset:2048 sc1
    buffer_store_dwordx4 v[180:183], v247, s[44:47], s74 offen offset:3072 sc1
    s_branch .LstageB
.LstageAV:
    s_barrier
    ds_read_b128 v[0:3], v228 offset:0
    ds_read_b128 v[216:219], v232 offset:0
    ds_read_b64_tr_b16 v[192:193], v243 offset:0
    ds_read_b64_tr_b16 v[194:195], v243 offset:256
    ds_read_b64_tr_b16 v[196:197], v243 offset:4096
    ds_read_b64_tr_b16 v[198:199], v243 offset:4352
    ds_read_b128 v[4:7], v229 offset:0
    ds_read_b128 v[220:223], v233 offset:0
    ds_read_b64_tr_b16 v[200:201], v243 offset:1024
    ds_read_b64_tr_b16 v[202:203], v243 offset:1280
    ds_read_b64_tr_b16 v[204:205], v243 offset:5120
    ds_read_b64_tr_b16 v[206:207], v243 offset:5376
    s_waitcnt lgkmcnt(6)
    v_mfma_f32_32x32x16_bf16 v[128:143], v[0:3], v[192:195], 0
    ds_read_b128 v[8:11], v230 offset:0
    ds_read_b128 v[224:227], v234 offset:0
    v_mfma_f32_32x32x16_bf16 v[144:159], v[216:219], v[192:195], 0
    ds_read_b64_tr_b16 v[208:209], v243 offset:2048
    ds_read_b64_tr_b16 v[210:211], v243 offset:2304
    v_mfma_f32_32x32x16_bf16 v[160:175], v[0:3], v[196:199], 0
    ds_read_b64_tr_b16 v[212:213], v243 offset:6144
    ds_read_b64_tr_b16 v[214:215], v243 offset:6400
    v_mfma_f32_32x32x16_bf16 v[176:191], v[216:219], v[196:199], 0
    s_waitcnt lgkmcnt(6)
    v_mfma_f32_32x32x16_bf16 v[128:143], v[4:7], v[200:203], v[128:143]
    ds_read_b128 v[12:15], v231 offset:0
    ds_read_b128 v[216:219], v235 offset:0
    v_mfma_f32_32x32x16_bf16 v[144:159], v[220:223], v[200:203], v[144:159]
    ds_read_b64_tr_b16 v[192:193], v243 offset:3072
    ds_read_b64_tr_b16 v[194:195], v243 offset:3328
    v_mfma_f32_32x32x16_bf16 v[160:175], v[4:7], v[204:207], v[160:175]
    ds_read_b64_tr_b16 v[196:197], v243 offset:7168
    ds_read_b64_tr_b16 v[198:199], v243 offset:7424
    v_mfma_f32_32x32x16_bf16 v[176:191], v[220:223], v[204:207], v[176:191]
    s_waitcnt lgkmcnt(6)
    v_mfma_f32_32x32x16_bf16 v[128:143], v[8:11], v[208:211], v[128:143]
    v_mfma_f32_32x32x16_bf16 v[144:159], v[224:227], v[208:211], v[144:159]
    v_mfma_f32_32x32x16_bf16 v[160:175], v[8:11], v[212:215], v[160:175]
    v_mfma_f32_32x32x16_bf16 v[176:191], v[224:227], v[212:215], v[176:191]
    s_waitcnt lgkmcnt(0)
    s_barrier
    v_mfma_f32_32x32x16_bf16 v[128:143], v[12:15], v[192:195], v[128:143]
    ds_read_b128 v[16:19], v228 offset:16384
    ds_read_b128 v[220:223], v232 offset:16384
    ds_read_b64_tr_b16 v[200:201], v243 offset:16384
    v_mfma_f32_32x32x16_bf16 v[144:159], v[216:219], v[192:195], v[144:159]
    ds_read_b64_tr_b16 v[202:203], v243 offset:16640
    ds_read_b64_tr_b16 v[204:205], v243 offset:20480
    ds_read_b64_tr_b16 v[206:207], v243 offset:20736
    v_mfma_f32_32x32x16_bf16 v[160:175], v[12:15], v[196:199], v[160:175]
    ds_read_b128 v[20:23], v229 offset:16384
    ds_read_b128 v[224:227], v233 offset:16384
    ds_read_b64_tr_b16 v[208:209], v243 offset:17408
    v_mfma_f32_32x32x16_bf16 v[176:191], v[216:219], v[196:199], v[176:191]
    ds_read_b64_tr_b16 v[210:211], v243 offset:17664
    ds_read_b64_tr_b16 v[212:213], v243 offset:21504
    ds_read_b64_tr_b16 v[214:215], v243 offset:21760
    s_waitcnt lgkmcnt(6)
    v_mfma_f32_32x32x16_bf16 v[128:143], v[16:19], v[200:203], v[128:143]
    ds_read_b128 v[24:27], v230 offset:16384
    ds_read_b128 v[216:219], v234 offset:16384
    v_mfma_f32_32x32x16_bf16 v[144:159], v[220:223], v[200:203], v[144:159]
    ds_read_b64_tr_b16 v[192:193], v243 offset:18432
    ds_read_b64_tr_b16 v[194:195], v243 offset:18688
    v_mfma_f32_32x32x16_bf16 v[160:175], v[16:19], v[204:207], v[160:175]
    ds_read_b64_tr_b16 v[196:197], v243 offset:22528
    ds_read_b64_tr_b16 v[198:199], v243 offset:22784
    v_mfma_f32_32x32x16_bf16 v[176:191], v[220:223], v[204:207], v[176:191]
    s_waitcnt lgkmcnt(6)
    v_mfma_f32_32x32x16_bf16 v[128:143], v[20:23], v[208:211], v[128:143]
    ds_read_b128 v[28:31], v231 offset:16384
    ds_read_b128 v[220:223], v235 offset:16384
    v_mfma_f32_32x32x16_bf16 v[144:159], v[224:227], v[208:211], v[144:159]
    ds_read_b64_tr_b16 v[200:201], v243 offset:19456
    ds_read_b64_tr_b16 v[202:203], v243 offset:19712
    v_mfma_f32_32x32x16_bf16 v[160:175], v[20:23], v[212:215], v[160:175]
    ds_read_b64_tr_b16 v[204:205], v243 offset:23552
    ds_read_b64_tr_b16 v[206:207], v243 offset:23808
    v_mfma_f32_32x32x16_bf16 v[176:191], v[224:227], v[212:215], v[176:191]
    s_waitcnt lgkmcnt(6)
    v_mfma_f32_32x32x16_bf16 v[128:143], v[24:27], v[192:195], v[128:143]
    v_mfma_f32_32x32x16_bf16 v[144:159], v[216:219], v[192:195], v[144:159]
    v_mfma_f32_32x32x16_bf16 v[160:175], v[24:27], v[196:199], v[160:175]
    v_mfma_f32_32x32x16_bf16 v[176:191], v[216:219], v[196:199], v[176:191]
    s_waitcnt lgkmcnt(0)
    s_barrier
    v_mfma_f32_32x32x16_bf16 v[128:143], v[28:31], v[200:203], v[128:143]
    ds_read_b128 v[32:35], v228 offset:32768
    ds_read_b128 v[224:227], v232 offset:32768
    ds_read_b64_tr_b16 v[208:209], v243 offset:32768
    v_mfma_f32_32x32x16_bf16 v[144:159], v[220:223], v[200:203], v[144:159]
    ds_read_b64_tr_b16 v[210:211], v243 offset:33024
    ds_read_b64_tr_b16 v[212:213], v243 offset:36864
    ds_read_b64_tr_b16 v[214:215], v243 offset:37120
    v_mfma_f32_32x32x16_bf16 v[160:175], v[28:31], v[204:207], v[160:175]
    ds_read_b128 v[36:39], v229 offset:32768
    ds_read_b128 v[216:219], v233 offset:32768
    ds_read_b64_tr_b16 v[192:193], v243 offset:33792
    v_mfma_f32_32x32x16_bf16 v[176:191], v[220:223], v[204:207], v[176:191]
    ds_read_b64_tr_b16 v[194:195], v243 offset:34048
    ds_read_b64_tr_b16 v[196:197], v243 offset:37888
    ds_read_b64_tr_b16 v[198:199], v243 offset:38144
    s_waitcnt lgkmcnt(6)
    v_mfma_f32_32x32x16_bf16 v[128:143], v[32:35], v[208:211], v[128:143]
    ds_read_b128 v[40:43], v230 offset:32768
    ds_read_b128 v[220:223], v234 offset:32768
    v_mfma_f32_32x32x16_bf16 v[144:159], v[224:227], v[208:211], v[144:159]
    ds_read_b64_tr_b16 v[200:201], v243 offset:34816
    ds_read_b64_tr_b16 v[202:203], v243 offset:35072
    v_mfma_f32_32x32x16_bf16 v[160:175], v[32:35], v[212:215], v[160:175]
    ds_read_b64_tr_b16 v[204:205], v243 offset:38912
    ds_read_b64_tr_b16 v[206:207], v243 offset:39168
    v_mfma_f32_32x32x16_bf16 v[176:191], v[224:227], v[212:215], v[176:191]
    s_waitcnt lgkmcnt(6)
    v_mfma_f32_32x32x16_bf16 v[128:143], v[36:39], v[192:195], v[128:143]
    ds_read_b128 v[44:47], v231 offset:32768
    ds_read_b128 v[224:227], v235 offset:32768
    v_mfma_f32_32x32x16_bf16 v[144:159], v[216:219], v[192:195], v[144:159]
    ds_read_b64_tr_b16 v[208:209], v243 offset:35840
    ds_read_b64_tr_b16 v[210:211], v243 offset:36096
    v_mfma_f32_32x32x16_bf16 v[160:175], v[36:39], v[196:199], v[160:175]
    ds_read_b64_tr_b16 v[212:213], v243 offset:39936
    ds_read_b64_tr_b16 v[214:215], v243 offset:40192
    v_mfma_f32_32x32x16_bf16 v[176:191], v[216:219], v[196:199], v[176:191]
    s_waitcnt lgkmcnt(6)
    v_mfma_f32_32x32x16_bf16 v[128:143], v[40:43], v[200:203], v[128:143]
    v_mfma_f32_32x32x16_bf16 v[144:159], v[220:223], v[200:203], v[144:159]
    v_mfma_f32_32x32x16_bf16 v[160:175], v[40:43], v[204:207], v[160:175]
    v_mfma_f32_32x32x16_bf16 v[176:191], v[220:223], v[204:207], v[176:191]
    s_waitcnt lgkmcnt(0)
    s_barrier
    v_mfma_f32_32x32x16_bf16 v[128:143], v[44:47], v[208:211], v[128:143]
    ds_read_b128 v[48:51], v228 offset:49152
    ds_read_b128 v[216:219], v232 offset:49152
    ds_read_b64_tr_b16 v[192:193], v243 offset:49152
    v_mfma_f32_32x32x16_bf16 v[144:159], v[224:227], v[208:211], v[144:159]
    ds_read_b64_tr_b16 v[194:195], v243 offset:49408
    ds_read_b64_tr_b16 v[196:197], v243 offset:53248
    ds_read_b64_tr_b16 v[198:199], v243 offset:53504
    v_mfma_f32_32x32x16_bf16 v[160:175], v[44:47], v[212:215], v[160:175]
    ds_read_b128 v[52:55], v229 offset:49152
    ds_read_b128 v[220:223], v233 offset:49152
    ds_read_b64_tr_b16 v[200:201], v243 offset:50176
    v_mfma_f32_32x32x16_bf16 v[176:191], v[224:227], v[212:215], v[176:191]
    ds_read_b64_tr_b16 v[202:203], v243 offset:50432
    ds_read_b64_tr_b16 v[204:205], v243 offset:54272
    ds_read_b64_tr_b16 v[206:207], v243 offset:54528
    s_waitcnt lgkmcnt(6)
    v_mfma_f32_32x32x16_bf16 v[128:143], v[48:51], v[192:195], v[128:143]
    ds_read_b128 v[56:59], v230 offset:49152
    ds_read_b128 v[224:227], v234 offset:49152
    v_mfma_f32_32x32x16_bf16 v[144:159], v[216:219], v[192:195], v[144:159]
    ds_read_b64_tr_b16 v[208:209], v243 offset:51200
    ds_read_b64_tr_b16 v[210:211], v243 offset:51456
    v_mfma_f32_32x32x16_bf16 v[160:175], v[48:51], v[196:199], v[160:175]
    ds_read_b64_tr_b16 v[212:213], v243 offset:55296
    ds_read_b64_tr_b16 v[214:215], v243 offset:55552
    v_mfma_f32_32x32x16_bf16 v[176:191], v[216:219], v[196:199], v[176:191]
    s_waitcnt lgkmcnt(6)
    v_mfma_f32_32x32x16_bf16 v[128:143], v[52:55], v[200:203], v[128:143]
    ds_read_b128 v[60:63], v231 offset:49152
    ds_read_b128 v[216:219], v235 offset:49152
    v_mfma_f32_32x32x16_bf16 v[144:159], v[220:223], v[200:203], v[144:159]
    ds_read_b64_tr_b16 v[192:193], v243 offset:52224
    ds_read_b64_tr_b16 v[194:195], v243 offset:52480
    v_mfma_f32_32x32x16_bf16 v[160:175], v[52:55], v[204:207], v[160:175]
    ds_read_b64_tr_b16 v[196:197], v243 offset:56320
    ds_read_b64_tr_b16 v[198:199], v243 offset:56576
    v_mfma_f32_32x32x16_bf16 v[176:191], v[220:223], v[204:207], v[176:191]
    s_waitcnt lgkmcnt(6)
    v_mfma_f32_32x32x16_bf16 v[128:143], v[56:59], v[208:211], v[128:143]
    v_mfma_f32_32x32x16_bf16 v[144:159], v[224:227], v[208:211], v[144:159]
    v_mfma_f32_32x32x16_bf16 v[160:175], v[56:59], v[212:215], v[160:175]
    v_mfma_f32_32x32x16_bf16 v[176:191], v[224:227], v[212:215], v[176:191]
    s_waitcnt lgkmcnt(0)
    s_barrier
    v_mfma_f32_32x32x16_bf16 v[128:143], v[60:63], v[192:195], v[128:143]
    ds_read_b128 v[64:67], v228 offset:0
    ds_read_b128 v[220:223], v232 offset:0
    ds_read_b64_tr_b16 v[200:201], v243 offset:0
    v_mfma_f32_32x32x16_bf16 v[144:159], v[216:219], v[192:195], v[144:159]
    ds_read_b64_tr_b16 v[202:203], v243 offset:256
    ds_read_b64_tr_b16 v[204:205], v243 offset:4096
    ds_read_b64_tr_b16 v[206:207], v243 offset:4352
    v_mfma_f32_32x32x16_bf16 v[160:175], v[60:63], v[196:199], v[160:175]
    ds_read_b128 v[68:71], v229 offset:0
    ds_read_b128 v[224:227], v233 offset:0
    ds_read_b64_tr_b16 v[208:209], v243 offset:1024
    v_mfma_f32_32x32x16_bf16 v[176:191], v[216:219], v[196:199], v[176:191]
    ds_read_b64_tr_b16 v[210:211], v243 offset:1280
    ds_read_b64_tr_b16 v[212:213], v243 offset:5120
    ds_read_b64_tr_b16 v[214:215], v243 offset:5376
    s_waitcnt lgkmcnt(6)
    v_mfma_f32_32x32x16_bf16 v[128:143], v[64:67], v[200:203], v[128:143]
    ds_read_b128 v[72:75], v230 offset:0
    ds_read_b128 v[216:219], v234 offset:0
    v_mfma_f32_32x32x16_bf16 v[144:159], v[220:223], v[200:203], v[144:159]
    ds_read_b64_tr_b16 v[192:193], v243 offset:2048
    ds_read_b64_tr_b16 v[194:195], v243 offset:2304
    v_mfma_f32_32x32x16_bf16 v[160:175], v[64:67], v[204:207], v[160:175]
    ds_read_b64_tr_b16 v[196:197], v243 offset:6144
    ds_read_b64_tr_b16 v[198:199], v243 offset:6400
    v_mfma_f32_32x32x16_bf16 v[176:191], v[220:223], v[204:207], v[176:191]
    s_waitcnt lgkmcnt(6)
    v_mfma_f32_32x32x16_bf16 v[128:143], v[68:71], v[208:211], v[128:143]
    ds_read_b128 v[76:79], v231 offset:0
    ds_read_b128 v[220:223], v235 offset:0
    v_mfma_f32_32x32x16_bf16 v[144:159], v[224:227], v[208:211], v[144:159]
    ds_read_b64_tr_b16 v[200:201], v243 offset:3072
    ds_read_b64_tr_b16 v[202:203], v243 offset:3328
    v_mfma_f32_32x32x16_bf16 v[160:175], v[68:71], v[212:215], v[160:175]
    ds_read_b64_tr_b16 v[204:205], v243 offset:7168
    ds_read_b64_tr_b16 v[206:207], v243 offset:7424
    v_mfma_f32_32x32x16_bf16 v[176:191], v[224:227], v[212:215], v[176:191]
    s_waitcnt lgkmcnt(6)
    v_mfma_f32_32x32x16_bf16 v[128:143], v[72:75], v[192:195], v[128:143]
    v_mfma_f32_32x32x16_bf16 v[144:159], v[216:219], v[192:195], v[144:159]
    v_mfma_f32_32x32x16_bf16 v[160:175], v[72:75], v[196:199], v[160:175]
    v_mfma_f32_32x32x16_bf16 v[176:191], v[216:219], v[196:199], v[176:191]
    s_waitcnt lgkmcnt(0)
    s_barrier
    v_mfma_f32_32x32x16_bf16 v[128:143], v[76:79], v[200:203], v[128:143]
    ds_read_b128 v[80:83], v228 offset:16384
    ds_read_b128 v[224:227], v232 offset:16384
    ds_read_b64_tr_b16 v[208:209], v243 offset:16384
    v_mfma_f32_32x32x16_bf16 v[144:159], v[220:223], v[200:203], v[144:159]
    ds_read_b64_tr_b16 v[210:211], v243 offset:16640
    ds_read_b64_tr_b16 v[212:213], v243 offset:20480
    ds_read_b64_tr_b16 v[214:215], v243 offset:20736
    v_mfma_f32_32x32x16_bf16 v[160:175], v[76:79], v[204:207], v[160:175]
    ds_read_b128 v[84:87], v229 offset:16384
    ds_read_b128 v[216:219], v233 offset:16384
    ds_read_b64_tr_b16 v[192:193], v243 offset:17408
    v_mfma_f32_32x32x16_bf16 v[176:191], v[220:223], v[204:207], v[176:191]
    ds_read_b64_tr_b16 v[194:195], v243 offset:17664
    ds_read_b64_tr_b16 v[196:197], v243 offset:21504
    ds_read_b64_tr_b16 v[198:199], v243 offset:21760
    s_waitcnt lgkmcnt(6)
    v_mfma_f32_32x32x16_bf16 v[128:143], v[80:83], v[208:211], v[128:143]
    ds_read_b128 v[88:91], v230 offset:16384
    ds_read_b128 v[220:223], v234 offset:16384
    v_mfma_f32_32x32x16_bf16 v[144:159], v[224:227], v[208:211], v[144:159]
    ds_read_b64_tr_b16 v[200:201], v243 offset:18432
    ds_read_b64_tr_b16 v[202:203], v243 offset:18688
    v_mfma_f32_32x32x16_bf16 v[160:175], v[80:83], v[212:215], v[160:175]
    ds_read_b64_tr_b16 v[204:205], v243 offset:22528
    ds_read_b64_tr_b16 v[206:207], v243 offset:22784
    v_mfma_f32_32x32x16_bf16 v[176:191], v[224:227], v[212:215], v[176:191]
    s_waitcnt lgkmcnt(6)
    v_mfma_f32_32x32x16_bf16 v[128:143], v[84:87], v[192:195], v[128:143]
    ds_read_b128 v[92:95], v231 offset:16384
    ds_read_b128 v[224:227], v235 offset:16384
    v_mfma_f32_32x32x16_bf16 v[144:159], v[216:219], v[192:195], v[144:159]
    ds_read_b64_tr_b16 v[208:209], v243 offset:19456
    ds_read_b64_tr_b16 v[210:211], v243 offset:19712
    v_mfma_f32_32x32x16_bf16 v[160:175], v[84:87], v[196:199], v[160:175]
    ds_read_b64_tr_b16 v[212:213], v243 offset:23552
    ds_read_b64_tr_b16 v[214:215], v243 offset:23808
    v_mfma_f32_32x32x16_bf16 v[176:191], v[216:219], v[196:199], v[176:191]
    s_waitcnt lgkmcnt(6)
    v_mfma_f32_32x32x16_bf16 v[128:143], v[88:91], v[200:203], v[128:143]
    v_mfma_f32_32x32x16_bf16 v[144:159], v[220:223], v[200:203], v[144:159]
    v_mfma_f32_32x32x16_bf16 v[160:175], v[88:91], v[204:207], v[160:175]
    v_mfma_f32_32x32x16_bf16 v[176:191], v[220:223], v[204:207], v[176:191]
    s_waitcnt lgkmcnt(0)
    s_barrier
    v_mfma_f32_32x32x16_bf16 v[128:143], v[92:95], v[208:211], v[128:143]
    ds_read_b128 v[96:99], v228 offset:32768
    ds_read_b128 v[216:219], v232 offset:32768
    ds_read_b64_tr_b16 v[192:193], v243 offset:32768
    v_mfma_f32_32x32x16_bf16 v[144:159], v[224:227], v[208:211], v[144:159]
    ds_read_b64_tr_b16 v[194:195], v243 offset:33024
    ds_read_b64_tr_b16 v[196:197], v243 offset:36864
    ds_read_b64_tr_b16 v[198:199], v243 offset:37120
    v_mfma_f32_32x32x16_bf16 v[160:175], v[92:95], v[212:215], v[160:175]
    ds_read_b128 v[100:103], v229 offset:32768
    ds_read_b128 v[220:223], v233 offset:32768
    ds_read_b64_tr_b16 v[200:201], v243 offset:33792
    v_mfma_f32_32x32x16_bf16 v[176:191], v[224:227], v[212:215], v[176:191]
    ds_read_b64_tr_b16 v[202:203], v243 offset:34048
    ds_read_b64_tr_b16 v[204:205], v243 offset:37888
    ds_read_b64_tr_b16 v[206:207], v243 offset:38144
    s_waitcnt lgkmcnt(6)
    v_mfma_f32_32x32x16_bf16 v[128:143], v[96:99], v[192:195], v[128:143]
    ds_read_b128 v[104:107], v230 offset:32768
    ds_read_b128 v[224:227], v234 offset:32768
    v_mfma_f32_32x32x16_bf16 v[144:159], v[216:219], v[192:195], v[144:159]
    ds_read_b64_tr_b16 v[208:209], v243 offset:34816
    ds_read_b64_tr_b16 v[210:211], v243 offset:35072
    v_mfma_f32_32x32x16_bf16 v[160:175], v[96:99], v[196:199], v[160:175]
    ds_read_b64_tr_b16 v[212:213], v243 offset:38912
    ds_read_b64_tr_b16 v[214:215], v243 offset:39168
    v_mfma_f32_32x32x16_bf16 v[176:191], v[216:219], v[196:199], v[176:191]
    s_waitcnt lgkmcnt(6)
    v_mfma_f32_32x32x16_bf16 v[128:143], v[100:103], v[200:203], v[128:143]
    ds_read_b128 v[108:111], v231 offset:32768
    ds_read_b128 v[216:219], v235 offset:32768
    v_mfma_f32_32x32x16_bf16 v[144:159], v[220:223], v[200:203], v[144:159]
    ds_read_b64_tr_b16 v[192:193], v243 offset:35840
    ds_read_b64_tr_b16 v[194:195], v243 offset:36096
    v_mfma_f32_32x32x16_bf16 v[160:175], v[100:103], v[204:207], v[160:175]
    ds_read_b64_tr_b16 v[196:197], v243 offset:39936
    ds_read_b64_tr_b16 v[198:199], v243 offset:40192
    v_mfma_f32_32x32x16_bf16 v[176:191], v[220:223], v[204:207], v[176:191]
    s_waitcnt lgkmcnt(6)
    v_mfma_f32_32x32x16_bf16 v[128:143], v[104:107], v[208:211], v[128:143]
    v_mfma_f32_32x32x16_bf16 v[144:159], v[224:227], v[208:211], v[144:159]
    v_mfma_f32_32x32x16_bf16 v[160:175], v[104:107], v[212:215], v[160:175]
    v_mfma_f32_32x32x16_bf16 v[176:191], v[224:227], v[212:215], v[176:191]
    s_waitcnt lgkmcnt(0)
    s_barrier
    v_mfma_f32_32x32x16_bf16 v[128:143], v[108:111], v[192:195], v[128:143]
    ds_read_b128 v[112:115], v228 offset:49152
    ds_read_b128 v[220:223], v232 offset:49152
    ds_read_b64_tr_b16 v[200:201], v243 offset:49152
    v_mfma_f32_32x32x16_bf16 v[144:159], v[216:219], v[192:195], v[144:159]
    ds_read_b64_tr_b16 v[202:203], v243 offset:49408
    ds_read_b64_tr_b16 v[204:205], v243 offset:53248
    ds_read_b64_tr_b16 v[206:207], v243 offset:53504
    v_mfma_f32_32x32x16_bf16 v[160:175], v[108:111], v[196:199], v[160:175]
    ds_read_b128 v[116:119], v229 offset:49152
    ds_read_b128 v[224:227], v233 offset:49152
    ds_read_b64_tr_b16 v[208:209], v243 offset:50176
    v_mfma_f32_32x32x16_bf16 v[176:191], v[216:219], v[196:199], v[176:191]
    ds_read_b64_tr_b16 v[210:211], v243 offset:50432
    ds_read_b64_tr_b16 v[212:213], v243 offset:54272
    ds_read_b64_tr_b16 v[214:215], v243 offset:54528
    s_waitcnt lgkmcnt(6)
    v_mfma_f32_32x32x16_bf16 v[128:143], v[112:115], v[200:203], v[128:143]
    ds_read_b128 v[120:123], v230 offset:49152
    ds_read_b128 v[216:219], v234 offset:49152
    v_mfma_f32_32x32x16_bf16 v[144:159], v[220:223], v[200:203], v[144:159]
    ds_read_b64_tr_b16 v[192:193], v243 offset:51200
    ds_read_b64_tr_b16 v[194:195], v243 offset:51456
    v_mfma_f32_32x32x16_bf16 v[160:175], v[112:115], v[204:207], v[160:175]
    ds_read_b64_tr_b16 v[196:197], v243 offset:55296
    ds_read_b64_tr_b16 v[198:199], v243 offset:55552
    v_mfma_f32_32x32x16_bf16 v[176:191], v[220:223], v[204:207], v[176:191]
    s_waitcnt lgkmcnt(6)
    v_mfma_f32_32x32x16_bf16 v[128:143], v[116:119], v[208:211], v[128:143]
    ds_read_b128 v[124:127], v231 offset:49152
    ds_read_b128 v[220:223], v235 offset:49152
    v_mfma_f32_32x32x16_bf16 v[144:159], v[224:227], v[208:211], v[144:159]
    ds_read_b64_tr_b16 v[200:201], v243 offset:52224
    ds_read_b64_tr_b16 v[202:203], v243 offset:52480
    v_mfma_f32_32x32x16_bf16 v[160:175], v[116:119], v[212:215], v[160:175]
    ds_read_b64_tr_b16 v[204:205], v243 offset:56320
    ds_read_b64_tr_b16 v[206:207], v243 offset:56576
    v_mfma_f32_32x32x16_bf16 v[176:191], v[224:227], v[212:215], v[176:191]
    s_waitcnt lgkmcnt(6)
    v_mfma_f32_32x32x16_bf16 v[128:143], v[120:123], v[192:195], v[128:143]
    v_mfma_f32_32x32x16_bf16 v[144:159], v[216:219], v[192:195], v[144:159]
    v_mfma_f32_32x32x16_bf16 v[160:175], v[120:123], v[196:199], v[160:175]
    v_mfma_f32_32x32x16_bf16 v[176:191], v[216:219], v[196:199], v[176:191]
    s_waitcnt lgkmcnt(0)
    v_mfma_f32_32x32x16_bf16 v[128:143], v[124:127], v[200:203], v[128:143]
    v_mfma_f32_32x32x16_bf16 v[144:159], v[220:223], v[200:203], v[144:159]
    v_mfma_f32_32x32x16_bf16 v[160:175], v[124:127], v[204:207], v[160:175]
    v_mfma_f32_32x32x16_bf16 v[176:191], v[220:223], v[204:207], v[176:191]
    s_lshl_b32 s72, s96, 9
    s_lshl_b32 s73, s79, 8
    s_add_u32 s72, s72, s73
    s_add_u32 s72, s72, s93
    s_lshl_b32 s72, s72, 10
    s_add_u32 s72, s72, 4194304
    s_xor_b32 s74, s72, 1024
    v_and_b32 v250, 15, v254
    v_lshrrev_b32 v251, 5, v254
    v_lshl_add_u32 v250, v251, 4, v250
    v_lshlrev_b32 v250, 4, v250
    v_bfe_u32 v251, v254, 4, 1
    v_lshl_add_u32 v250, v251, 16, v250
    v_cvt_pk_bf16_f32 v128, v128, v129
    v_cvt_pk_bf16_f32 v129, v130, v131
    v_cvt_pk_bf16_f32 v130, v132, v133
    v_cvt_pk_bf16_f32 v131, v134, v135
    v_cvt_pk_bf16_f32 v132, v136, v137
    v_cvt_pk_bf16_f32 v133, v138, v139
    v_cvt_pk_bf16_f32 v134, v140, v141
    v_cvt_pk_bf16_f32 v135, v142, v143
    buffer_store_dwordx4 v[128:131], v250, s[44:47], s72 offen sc1
    buffer_store_dwordx4 v[132:135], v250, s[44:47], s72 offen offset:512 sc1
    v_cvt_pk_bf16_f32 v144, v144, v145
    v_cvt_pk_bf16_f32 v145, v146, v147
    v_cvt_pk_bf16_f32 v146, v148, v149
    v_cvt_pk_bf16_f32 v147, v150, v151
    v_cvt_pk_bf16_f32 v148, v152, v153
    v_cvt_pk_bf16_f32 v149, v154, v155
    v_cvt_pk_bf16_f32 v150, v156, v157
    v_cvt_pk_bf16_f32 v151, v158, v159
    buffer_store_dwordx4 v[144:147], v250, s[44:47], s74 offen sc1
    buffer_store_dwordx4 v[148:151], v250, s[44:47], s74 offen offset:512 sc1
    s_add_u32 s72, s72, 0x20000
    s_add_u32 s74, s74, 0x20000
    v_cvt_pk_bf16_f32 v160, v160, v161
    v_cvt_pk_bf16_f32 v161, v162, v163
    v_cvt_pk_bf16_f32 v162, v164, v165
    v_cvt_pk_bf16_f32 v163, v166, v167
    v_cvt_pk_bf16_f32 v164, v168, v169
    v_cvt_pk_bf16_f32 v165, v170, v171
    v_cvt_pk_bf16_f32 v166, v172, v173
    v_cvt_pk_bf16_f32 v167, v174, v175
    buffer_store_dwordx4 v[160:163], v250, s[44:47], s72 offen sc1
    buffer_store_dwordx4 v[164:167], v250, s[44:47], s72 offen offset:512 sc1
    v_cvt_pk_bf16_f32 v176, v176, v177
    v_cvt_pk_bf16_f32 v177, v178, v179
    v_cvt_pk_bf16_f32 v178, v180, v181
    v_cvt_pk_bf16_f32 v179, v182, v183
    v_cvt_pk_bf16_f32 v180, v184, v185
    v_cvt_pk_bf16_f32 v181, v186, v187
    v_cvt_pk_bf16_f32 v182, v188, v189
    v_cvt_pk_bf16_f32 v183, v190, v191
    buffer_store_dwordx4 v[176:179], v250, s[44:47], s74 offen sc1
    buffer_store_dwordx4 v[180:183], v250, s[44:47], s74 offen offset:512 sc1
.LstageB:
    s_cmp_eq_u32 s7, 13
    s_cbranch_scc1 .Lgate
    s_barrier
    v_mov_b32 v250, 155648
    ds_read_b32 v251, v250
    ds_read_b64_tr_b16 v[192:193], v242 offset:0
    ds_read_b64_tr_b16 v[194:195], v242 offset:256
    ds_read_b64_tr_b16 v[196:197], v242 offset:4096
    ds_read_b64_tr_b16 v[198:199], v242 offset:4352
    ds_read_b64_tr_b16 v[200:201], v242 offset:1024
    ds_read_b64_tr_b16 v[202:203], v242 offset:1280
    ds_read_b64_tr_b16 v[204:205], v242 offset:5120
    ds_read_b64_tr_b16 v[206:207], v242 offset:5376
    s_waitcnt lgkmcnt(4)
    v_mfma_f32_32x32x16_bf16 v[128:143], v[192:195], v[0:3], 0
    ds_read_b64_tr_b16 v[208:209], v242 offset:2048
    ds_read_b64_tr_b16 v[210:211], v242 offset:2304
    v_mfma_f32_32x32x16_bf16 v[144:159], v[196:199], v[0:3], 0
    ds_read_b64_tr_b16 v[212:213], v242 offset:6144
    ds_read_b64_tr_b16 v[214:215], v242 offset:6400
    s_waitcnt lgkmcnt(4)
    v_mfma_f32_32x32x16_bf16 v[128:143], v[200:203], v[4:7], v[128:143]
    ds_read_b64_tr_b16 v[192:193], v242 offset:3072
    ds_read_b64_tr_b16 v[194:195], v242 offset:3328
    v_mfma_f32_32x32x16_bf16 v[144:159], v[204:207], v[4:7], v[144:159]
    ds_read_b64_tr_b16 v[196:197], v242 offset:7168
    ds_read_b64_tr_b16 v[198:199], v242 offset:7424
    s_waitcnt lgkmcnt(4)
    v_readfirstlane_b32 s13, v251
    v_mfma_f32_32x32x16_bf16 v[128:143], v[208:211], v[8:11], v[128:143]
    ds_read_b64_tr_b16 v[200:201], v242 offset:8192
    ds_read_b64_tr_b16 v[202:203], v242 offset:8448
    v_mfma_f32_32x32x16_bf16 v[144:159], v[212:215], v[8:11], v[144:159]
    ds_read_b64_tr_b16 v[204:205], v242 offset:12288
    ds_read_b64_tr_b16 v[206:207], v242 offset:12544
    s_waitcnt lgkmcnt(4)
    v_mfma_f32_32x32x16_bf16 v[128:143], v[192:195], v[12:15], v[128:143]
    ds_read_b64_tr_b16 v[208:209], v242 offset:9216
    ds_read_b64_tr_b16 v[210:211], v242 offset:9472
    v_mfma_f32_32x32x16_bf16 v[144:159], v[196:199], v[12:15], v[144:159]
    ds_read_b64_tr_b16 v[212:213], v242 offset:13312
    ds_read_b64_tr_b16 v[214:215], v242 offset:13568
    s_waitcnt lgkmcnt(4)
    v_mfma_f32_32x32x16_bf16 v[128:143], v[200:203], v[16:19], v[128:143]
    ds_read_b64_tr_b16 v[192:193], v242 offset:10240
    ds_read_b64_tr_b16 v[194:195], v242 offset:10496
    v_mfma_f32_32x32x16_bf16 v[144:159], v[204:207], v[16:19], v[144:159]
    ds_read_b64_tr_b16 v[196:197], v242 offset:14336
    ds_read_b64_tr_b16 v[198:199], v242 offset:14592
    s_waitcnt lgkmcnt(4)
    v_mfma_f32_32x32x16_bf16 v[128:143], v[208:211], v[20:23], v[128:143]
    ds_read_b64_tr_b16 v[200:201], v242 offset:11264
    ds_read_b64_tr_b16 v[202:203], v242 offset:11520
    v_mfma_f32_32x32x16_bf16 v[144:159], v[212:215], v[20:23], v[144:159]
    ds_read_b64_tr_b16 v[204:205], v242 offset:15360
    ds_read_b64_tr_b16 v[206:207], v242 offset:15616
    s_waitcnt lgkmcnt(4)
    v_mfma_f32_32x32x16_bf16 v[128:143], v[192:195], v[24:27], v[128:143]
    ds_read_b64_tr_b16 v[208:209], v240 offset:0
    ds_read_b64_tr_b16 v[210:211], v240 offset:256
    v_mfma_f32_32x32x16_bf16 v[144:159], v[196:199], v[24:27], v[144:159]
    ds_read_b64_tr_b16 v[212:213], v240 offset:4096
    ds_read_b64_tr_b16 v[214:215], v240 offset:4352
    s_waitcnt lgkmcnt(4)
    v_mfma_f32_32x32x16_bf16 v[128:143], v[200:203], v[28:31], v[128:143]
    ds_read_b64_tr_b16 v[192:193], v240 offset:1024
    ds_read_b64_tr_b16 v[194:195], v240 offset:1280
    v_mfma_f32_32x32x16_bf16 v[144:159], v[204:207], v[28:31], v[144:159]
    ds_read_b64_tr_b16 v[196:197], v240 offset:5120
    ds_read_b64_tr_b16 v[198:199], v240 offset:5376
    s_waitcnt lgkmcnt(4)
    v_mfma_f32_32x32x16_bf16 v[128:143], v[208:211], v[32:35], v[128:143]
    ds_read_b64_tr_b16 v[200:201], v240 offset:2048
    ds_read_b64_tr_b16 v[202:203], v240 offset:2304
    v_mfma_f32_32x32x16_bf16 v[144:159], v[212:215], v[32:35], v[144:159]
    ds_read_b64_tr_b16 v[204:205], v240 offset:6144
    ds_read_b64_tr_b16 v[206:207], v240 offset:6400
    s_waitcnt lgkmcnt(4)
    v_mfma_f32_32x32x16_bf16 v[128:143], v[192:195], v[36:39], v[128:143]
    ds_read_b64_tr_b16 v[208:209], v240 offset:3072
    ds_read_b64_tr_b16 v[210:211], v240 offset:3328
    v_mfma_f32_32x32x16_bf16 v[144:159], v[196:199], v[36:39], v[144:159]
    ds_read_b64_tr_b16 v[212:213], v240 offset:7168
    ds_read_b64_tr_b16 v[214:215], v240 offset:7424
    s_waitcnt lgkmcnt(4)
    v_mfma_f32_32x32x16_bf16 v[128:143], v[200:203], v[40:43], v[128:143]
    ds_read_b64_tr_b16 v[192:193], v240 offset:8192
    ds_read_b64_tr_b16 v[194:195], v240 offset:8448
    v_mfma_f32_32x32x16_bf16 v[144:159], v[204:207], v[40:43], v[144:159]
    ds_read_b64_tr_b16 v[196:197], v240 offset:12288
    ds_read_b64_tr_b16 v[198:199], v240 offset:12544
    s_waitcnt lgkmcnt(4)
    v_mfma_f32_32x32x16_bf16 v[128:143], v[208:211], v[44:47], v[128:143]
    ds_read_b64_tr_b16 v[200:201], v240 offset:9216
    ds_read_b64_tr_b16 v[202:203], v240 offset:9472
    v_mfma_f32_32x32x16_bf16 v[144:159], v[212:215], v[44:47], v[144:159]
    ds_read_b64_tr_b16 v[204:205], v240 offset:13312
    ds_read_b64_tr_b16 v[206:207], v240 offset:13568
    s_waitcnt lgkmcnt(4)
    s_waitcnt vmcnt(0)
    s_mov_b64 exec, 1
    v_mov_b32 v248, 0
    v_mov_b32 v249, s13
    s_add_u32 s72, s76, 0x1000
    buffer_store_dword v249, v248, s[44:47], s72 offen
    buffer_store_dword v249, v248, s[44:47], s76 offen sc1
    s_mov_b64 exec, -1
    v_mfma_f32_32x32x16_bf16 v[128:143], v[192:195], v[48:51], v[128:143]
    ds_read_b64_tr_b16 v[208:209], v240 offset:10240
    ds_read_b64_tr_b16 v[210:211], v240 offset:10496
    v_mfma_f32_32x32x16_bf16 v[144:159], v[196:199], v[48:51], v[144:159]
    ds_read_b64_tr_b16 v[212:213], v240 offset:14336
    ds_read_b64_tr_b16 v[214:215], v240 offset:14592
    s_waitcnt lgkmcnt(4)
    v_mfma_f32_32x32x16_bf16 v[128:143], v[200:203], v[52:55], v[128:143]
    ds_read_b64_tr_b16 v[192:193], v240 offset:11264
    ds_read_b64_tr_b16 v[194:195], v240 offset:11520
    v_mfma_f32_32x32x16_bf16 v[144:159], v[204:207], v[52:55], v[144:159]
    ds_read_b64_tr_b16 v[196:197], v240 offset:15360
    ds_read_b64_tr_b16 v[198:199], v240 offset:15616
    s_waitcnt lgkmcnt(4)
    s_barrier
    v_mfma_f32_32x32x16_bf16 v[128:143], v[208:211], v[56:59], v[128:143]
    ds_read_b64_tr_b16 v[200:201], v241 offset:8192
    ds_read_b64_tr_b16 v[202:203], v241 offset:8448
    v_mfma_f32_32x32x16_bf16 v[144:159], v[212:215], v[56:59], v[144:159]
    ds_read_b64_tr_b16 v[204:205], v241 offset:12288
    ds_read_b64_tr_b16 v[206:207], v241 offset:12544
    s_waitcnt lgkmcnt(4)
    v_mfma_f32_32x32x16_bf16 v[128:143], v[192:195], v[60:63], v[128:143]
    ds_read_b64_tr_b16 v[208:209], v241 offset:9216
    ds_read_b64_tr_b16 v[210:211], v241 offset:9472
    v_mfma_f32_32x32x16_bf16 v[144:159], v[196:199], v[60:63], v[144:159]
    ds_read_b64_tr_b16 v[212:213], v241 offset:13312
    ds_read_b64_tr_b16 v[214:215], v241 offset:13568
    s_waitcnt lgkmcnt(4)
    v_mfma_f32_32x32x16_bf16 v[128:143], v[200:203], v[64:67], v[128:143]
    ds_read_b64_tr_b16 v[192:193], v241 offset:10240
    ds_read_b64_tr_b16 v[194:195], v241 offset:10496
    v_mfma_f32_32x32x16_bf16 v[144:159], v[204:207], v[64:67], v[144:159]
    ds_read_b64_tr_b16 v[196:197], v241 offset:14336
    ds_read_b64_tr_b16 v[198:199], v241 offset:14592
    s_waitcnt lgkmcnt(4)
    v_mfma_f32_32x32x16_bf16 v[128:143], v[208:211], v[68:71], v[128:143]
    ds_read_b64_tr_b16 v[200:201], v241 offset:11264
    ds_read_b64_tr_b16 v[202:203], v241 offset:11520
    v_mfma_f32_32x32x16_bf16 v[144:159], v[212:215], v[68:71], v[144:159]
    ds_read_b64_tr_b16 v[204:205], v241 offset:15360
    ds_read_b64_tr_b16 v[206:207], v241 offset:15616
    s_waitcnt lgkmcnt(4)
    v_mfma_f32_32x32x16_bf16 v[128:143], v[192:195], v[72:75], v[128:143]
    ds_read_b64_tr_b16 v[208:209], v240 offset:16384
    ds_read_b64_tr_b16 v[210:211], v240 offset:16640
    v_mfma_f32_32x32x16_bf16 v[144:159], v[196:199], v[72:75], v[144:159]
    ds_read_b64_tr_b16 v[212:213], v240 offset:20480
    ds_read_b64_tr_b16 v[214:215], v240 offset:20736
    s_waitcnt lgkmcnt(4)
    v_mfma_f32_32x32x16_bf16 v[128:143], v[200:203], v[76:79], v[128:143]
    ds_read_b64_tr_b16 v[192:193], v240 offset:17408
    ds_read_b64_tr_b16 v[194:195], v240 offset:17664
    v_mfma_f32_32x32x16_bf16 v[144:159], v[204:207], v[76:79], v[144:159]
    ds_read_b64_tr_b16 v[196:197], v240 offset:21504
    ds_read_b64_tr_b16 v[198:199], v240 offset:21760
    s_waitcnt lgkmcnt(4)
    v_mfma_f32_32x32x16_bf16 v[128:143], v[208:211], v[80:83], v[128:143]
    ds_read_b64_tr_b16 v[200:201], v240 offset:18432
    ds_read_b64_tr_b16 v[202:203], v240 offset:18688
    v_mfma_f32_32x32x16_bf16 v[144:159], v[212:215], v[80:83], v[144:159]
    ds_read_b64_tr_b16 v[204:205], v240 offset:22528
    ds_read_b64_tr_b16 v[206:207], v240 offset:22784
    s_waitcnt lgkmcnt(4)
    v_mfma_f32_32x32x16_bf16 v[128:143], v[192:195], v[84:87], v[128:143]
    ds_read_b64_tr_b16 v[208:209], v240 offset:19456
    ds_read_b64_tr_b16 v[210:211], v240 offset:19712
    v_mfma_f32_32x32x16_bf16 v[144:159], v[196:199], v[84:87], v[144:159]
    ds_read_b64_tr_b16 v[212:213], v240 offset:23552
    ds_read_b64_tr_b16 v[214:215], v240 offset:23808
    s_waitcnt lgkmcnt(4)
    v_mfma_f32_32x32x16_bf16 v[128:143], v[200:203], v[88:91], v[128:143]
    ds_read_b64_tr_b16 v[192:193], v240 offset:24576
    ds_read_b64_tr_b16 v[194:195], v240 offset:24832
    v_mfma_f32_32x32x16_bf16 v[144:159], v[204:207], v[88:91], v[144:159]
    ds_read_b64_tr_b16 v[196:197], v240 offset:28672
    ds_read_b64_tr_b16 v[198:199], v240 offset:28928
    s_waitcnt lgkmcnt(4)
    v_mfma_f32_32x32x16_bf16 v[128:143], v[208:211], v[92:95], v[128:143]
    ds_read_b64_tr_b16 v[200:201], v240 offset:25600
    ds_read_b64_tr_b16 v[202:203], v240 offset:25856
    v_mfma_f32_32x32x16_bf16 v[144:159], v[212:215], v[92:95], v[144:159]
    ds_read_b64_tr_b16 v[204:205], v240 offset:29696
    ds_read_b64_tr_b16 v[206:207], v240 offset:29952
    s_waitcnt lgkmcnt(4)
    v_mfma_f32_32x32x16_bf16 v[128:143], v[192:195], v[96:99], v[128:143]
    ds_read_b64_tr_b16 v[208:209], v240 offset:26624
    ds_read_b64_tr_b16 v[210:211], v240 offset:26880
    v_mfma_f32_32x32x16_bf16 v[144:159], v[196:199], v[96:99], v[144:159]
    ds_read_b64_tr_b16 v[212:213], v240 offset:30720
    ds_read_b64_tr_b16 v[214:215], v240 offset:30976
    s_waitcnt lgkmcnt(4)
    v_mfma_f32_32x32x16_bf16 v[128:143], v[200:203], v[100:103], v[128:143]
    ds_read_b64_tr_b16 v[192:193], v240 offset:27648
    ds_read_b64_tr_b16 v[194:195], v240 offset:27904
    v_mfma_f32_32x32x16_bf16 v[144:159], v[204:207], v[100:103], v[144:159]
    ds_read_b64_tr_b16 v[196:197], v240 offset:31744
    ds_read_b64_tr_b16 v[198:199], v240 offset:32000
    s_waitcnt lgkmcnt(4)
    v_mfma_f32_32x32x16_bf16 v[128:143], v[208:211], v[104:107], v[128:143]
    ds_read_b64_tr_b16 v[200:201], v241 offset:16384
    ds_read_b64_tr_b16 v[202:203], v241 offset:16640
    v_mfma_f32_32x32x16_bf16 v[144:159], v[212:215], v[104:107], v[144:159]
    ds_read_b64_tr_b16 v[204:205], v241 offset:20480
    ds_read_b64_tr_b16 v[206:207], v241 offset:20736
    s_waitcnt lgkmcnt(4)
    v_mfma_f32_32x32x16_bf16 v[128:143], v[192:195], v[108:111], v[128:143]
    ds_read_b64_tr_b16 v[208:209], v241 offset:17408
    ds_read_b64_tr_b16 v[210:211], v241 offset:17664
    v_mfma_f32_32x32x16_bf16 v[144:159], v[196:199], v[108:111], v[144:159]
    ds_read_b64_tr_b16 v[212:213], v241 offset:21504
    ds_read_b64_tr_b16 v[214:215], v241 offset:21760
    s_waitcnt lgkmcnt(4)
    v_mfma_f32_32x32x16_bf16 v[128:143], v[200:203], v[112:115], v[128:143]
    ds_read_b64_tr_b16 v[192:193], v241 offset:18432
    ds_read_b64_tr_b16 v[194:195], v241 offset:18688
    v_mfma_f32_32x32x16_bf16 v[144:159], v[204:207], v[112:115], v[144:159]
    ds_read_b64_tr_b16 v[196:197], v241 offset:22528
    ds_read_b64_tr_b16 v[198:199], v241 offset:22784
    s_waitcnt lgkmcnt(4)
    v_mfma_f32_32x32x16_bf16 v[128:143], v[208:211], v[116:119], v[128:143]
    ds_read_b64_tr_b16 v[200:201], v241 offset:19456
    ds_read_b64_tr_b16 v[202:203], v241 offset:19712
    v_mfma_f32_32x32x16_bf16 v[144:159], v[212:215], v[116:119], v[144:159]
    ds_read_b64_tr_b16 v[204:205], v241 offset:23552
    ds_read_b64_tr_b16 v[206:207], v241 offset:23808
    s_waitcnt lgkmcnt(4)
    v_mfma_f32_32x32x16_bf16 v[128:143], v[192:195], v[120:123], v[128:143]
    v_mfma_f32_32x32x16_bf16 v[144:159], v[196:199], v[120:123], v[144:159]
    s_waitcnt lgkmcnt(0)
    v_mfma_f32_32x32x16_bf16 v[128:143], v[200:203], v[124:127], v[128:143]
    v_mfma_f32_32x32x16_bf16 v[144:159], v[204:207], v[124:127], v[144:159]
    s_mul_i32 s72, s93, 118
    s_lshl_b32 s73, s94, 1
    s_add_u32 s72, s72, s73
    s_lshl_b32 s72, s72, 10
    s_add_u32 s72, s72, 6291456
    s_nop 6
    v_cvt_pk_bf16_f32 v128, v128, v129
    v_cvt_pk_bf16_f32 v129, v130, v131
    v_cvt_pk_bf16_f32 v130, v132, v133
    v_cvt_pk_bf16_f32 v131, v134, v135
    v_cvt_pk_bf16_f32 v132, v136, v137
    v_cvt_pk_bf16_f32 v133, v138, v139
    v_cvt_pk_bf16_f32 v134, v140, v141
    v_cvt_pk_bf16_f32 v135, v142, v143
    v_pk_max_i16 v128, v128, 0
    v_pk_max_i16 v129, v129, 0
    v_pk_max_i16 v130, v130, 0
    v_pk_max_i16 v131, v131, 0
    v_pk_max_i16 v132, v132, 0
    v_pk_max_i16 v133, v133, 0
    v_pk_max_i16 v134, v134, 0
    v_pk_max_i16 v135, v135, 0
    s_add_u32 s73, s94, 0
    s_cmp_lt_u32 s73, 43
    s_cselect_b32 s73, s72, 0x40000000
    buffer_store_dwordx4 v[128:131], v247, s[44:47], s73 offen offset:0 sc1
    buffer_store_dwordx4 v[132:135], v247, s[44:47], s73 offen offset:1024 sc1
    v_cvt_pk_bf16_f32 v144, v144, v145
    v_cvt_pk_bf16_f32 v145, v146, v147
    v_cvt_pk_bf16_f32 v146, v148, v149
    v_cvt_pk_bf16_f32 v147, v150, v151
    v_cvt_pk_bf16_f32 v148, v152, v153
    v_cvt_pk_bf16_f32 v149, v154, v155
    v_cvt_pk_bf16_f32 v150, v156, v157
    v_cvt_pk_bf16_f32 v151, v158, v159
    v_pk_max_i16 v144, v144, 0
    v_pk_max_i16 v145, v145, 0
    v_pk_max_i16 v146, v146, 0
    v_pk_max_i16 v147, v147, 0
    v_pk_max_i16 v148, v148, 0
    v_pk_max_i16 v149, v149, 0
    v_pk_max_i16 v150, v150, 0
    v_pk_max_i16 v151, v151, 0
    s_add_u32 s73, s94, 1
    s_cmp_lt_u32 s73, 43
    s_cselect_b32 s73, s72, 0x40000000
    buffer_store_dwordx4 v[144:147], v247, s[44:47], s73 offen offset:2048 sc1
    buffer_store_dwordx4 v[148:151], v247, s[44:47], s73 offen offset:3072 sc1
    s_branch .Lattn
.Lgate:
    s_lshl_b32 s75, s3, 10
    s_add_u32 s75, s75, 114688
    s_barrier
    s_mov_b32 m0, s75
    s_nop 0
    buffer_load_dwordx4 v247, s[68:71], 0 offen lds
    v_mov_b32 v250, 155648
    ds_read_b32 v251, v250
    s_waitcnt vmcnt(0) lgkmcnt(0)
    v_readfirstlane_b32 s13, v251
    s_nop 1
    s_mov_b64 exec, 1
    v_mov_b32 v248, 0
    v_mov_b32 v249, s13
    s_add_u32 s72, s76, 0x1000
    buffer_store_dword v249, v248, s[44:47], s72 offen
    buffer_store_dword v249, v248, s[44:47], s76 offen sc1
    s_mov_b64 exec, -1
    s_barrier
    v_lshrrev_b32 v248, 5, v254
    v_lshlrev_b32 v248, 4, v248
    v_add_u32 v248, s75, v248
    s_mov_b32 s73, s12
    s_lshl_b32 s74, s73, 7
    v_add_u32 v249, s74, v248
    ds_read_b128 v[144:147], v249 offset:0
    ds_read_b128 v[148:151], v249 offset:32
    ds_read_b128 v[152:155], v249 offset:64
    ds_read_b128 v[156:159], v249 offset:96
    s_add_u32 s73, s73, 1
    s_and_b32 s73, s73, 7
    s_waitcnt lgkmcnt(0)
    v_mfma_f32_32x32x16_bf16 v[128:143], v[144:147], v[0:3], 0
    v_mfma_f32_32x32x16_bf16 v[128:143], v[148:151], v[4:7], v[128:143]
    v_mfma_f32_32x32x16_bf16 v[128:143], v[152:155], v[8:11], v[128:143]
    v_mfma_f32_32x32x16_bf16 v[128:143], v[156:159], v[12:15], v[128:143]
    s_lshl_b32 s74, s73, 7
    v_add_u32 v249, s74, v248
    ds_read_b128 v[160:163], v249 offset:0
    ds_read_b128 v[164:167], v249 offset:32
    ds_read_b128 v[168:171], v249 offset:64
    ds_read_b128 v[172:175], v249 offset:96
    s_add_u32 s73, s73, 1
    s_and_b32 s73, s73, 7
    s_waitcnt lgkmcnt(0)
    v_mfma_f32_32x32x16_bf16 v[128:143], v[160:163], v[16:19], v[128:143]
    v_mfma_f32_32x32x16_bf16 v[128:143], v[164:167], v[20:23], v[128:143]
    v_mfma_f32_32x32x16_bf16 v[128:143], v[168:171], v[24:27], v[128:143]
    v_mfma_f32_32x32x16_bf16 v[128:143], v[172:175], v[28:31], v[128:143]
    s_lshl_b32 s74, s73, 7
    v_add_u32 v249, s74, v248
    ds_read_b128 v[144:147], v249 offset:0
    ds_read_b128 v[148:151], v249 offset:32
    ds_read_b128 v[152:155], v249 offset:64
    ds_read_b128 v[156:159], v249 offset:96
    s_add_u32 s73, s73, 1
    s_and_b32 s73, s73, 7
    s_waitcnt lgkmcnt(0)
    v_mfma_f32_32x32x16_bf16 v[128:143], v[144:147], v[32:35], v[128:143]
    v_mfma_f32_32x32x16_bf16 v[128:143], v[148:151], v[36:39], v[128:143]
    v_mfma_f32_32x32x16_bf16 v[128:143], v[152:155], v[40:43], v[128:143]
    v_mfma_f32_32x32x16_bf16 v[128:143], v[156:159], v[44:47], v[128:143]
    s_lshl_b32 s74, s73, 7
    v_add_u32 v249, s74, v248
    ds_read_b128 v[160:163], v249 offset:0
    ds_read_b128 v[164:167], v249 offset:32
    ds_read_b128 v[168:171], v249 offset:64
    ds_read_b128 v[172:175], v249 offset:96
    s_add_u32 s73, s73, 1
    s_and_b32 s73, s73, 7
    s_waitcnt lgkmcnt(0)
    v_mfma_f32_32x32x16_bf16 v[128:143], v[160:163], v[48:51], v[128:143]
    v_mfma_f32_32x32x16_bf16 v[128:143], v[164:167], v[52:55], v[128:143]
    v_mfma_f32_32x32x16_bf16 v[128:143], v[168:171], v[56:59], v[128:143]
    v_mfma_f32_32x32x16_bf16 v[128:143], v[172:175], v[60:63], v[128:143]
    s_lshl_b32 s74, s73, 7
    v_add_u32 v249, s74, v248
    ds_read_b128 v[144:147], v249 offset:0
    ds_read_b128 v[148:151], v249 offset:32
    ds_read_b128 v[152:155], v249 offset:64
    ds_read_b128 v[156:159], v249 offset:96
    s_add_u32 s73, s73, 1
    s_and_b32 s73, s73, 7
    s_waitcnt lgkmcnt(0)
    v_mfma_f32_32x32x16_bf16 v[128:143], v[144:147], v[64:67], v[128:143]
    v_mfma_f32_32x32x16_bf16 v[128:143], v[148:151], v[68:71], v[128:143]
    v_mfma_f32_32x32x16_bf16 v[128:143], v[152:155], v[72:75], v[128:143]
    v_mfma_f32_32x32x16_bf16 v[128:143], v[156:159], v[76:79], v[128:143]
    s_lshl_b32 s74, s73, 7
    v_add_u32 v249, s74, v248
    ds_read_b128 v[160:163], v249 offset:0
    ds_read_b128 v[164:167], v249 offset:32
    ds_read_b128 v[168:171], v249 offset:64
    ds_read_b128 v[172:175], v249 offset:96
    s_add_u32 s73, s73, 1
    s_and_b32 s73, s73, 7
    s_waitcnt lgkmcnt(0)
    v_mfma_f32_32x32x16_bf16 v[128:143], v[160:163], v[80:83], v[128:143]
    v_mfma_f32_32x32x16_bf16 v[128:143], v[164:167], v[84:87], v[128:143]
    v_mfma_f32_32x32x16_bf16 v[128:143], v[168:171], v[88:91], v[128:143]
    v_mfma_f32_32x32x16_bf16 v[128:143], v[172:175], v[92:95], v[128:143]
    s_lshl_b32 s74, s73, 7
    v_add_u32 v249, s74, v248
    ds_read_b128 v[144:147], v249 offset:0
    ds_read_b128 v[148:151], v249 offset:32
    ds_read_b128 v[152:155], v249 offset:64
    ds_read_b128 v[156:159], v249 offset:96
    s_add_u32 s73, s73, 1
    s_and_b32 s73, s73, 7
    s_waitcnt lgkmcnt(0)
    v_mfma_f32_32x32x16_bf16 v[128:143], v[144:147], v[96:99], v[128:143]
    v_mfma_f32_32x32x16_bf16 v[128:143], v[148:151], v[100:103], v[128:143]
    v_mfma_f32_32x32x16_bf16 v[128:143], v[152:155], v[104:107], v[128:143]
    v_mfma_f32_32x32x16_bf16 v[128:143], v[156:159], v[108:111], v[128:143]
    s_lshl_b32 s74, s73, 7
    v_add_u32 v249, s74, v248
    ds_read_b128 v[160:163], v249 offset:0
    ds_read_b128 v[164:167], v249 offset:32
    ds_read_b128 v[168:171], v249 offset:64
    ds_read_b128 v[172:175], v249 offset:96
    s_add_u32 s73, s73, 1
    s_and_b32 s73, s73, 7
    s_waitcnt lgkmcnt(0)
    v_mfma_f32_32x32x16_bf16 v[128:143], v[160:163], v[112:115], v[128:143]
    v_mfma_f32_32x32x16_bf16 v[128:143], v[164:167], v[116:119], v[128:143]
    v_mfma_f32_32x32x16_bf16 v[128:143], v[168:171], v[120:123], v[128:143]
    v_mfma_f32_32x32x16_bf16 v[128:143], v[172:175], v[124:127], v[128:143]
    s_nop 15
    v_cvt_pk_bf16_f32 v128, v128, v128
    v_lshlrev_b32 v128, 16, v128
    v_mul_f32 v128, 0xbfb8aa3b, v128
    v_exp_f32 v128, v128
    s_nop 0
    v_add_f32 v128, 1.0, v128
    v_rcp_f32 v128, v128
    s_nop 0
    v_cvt_pk_bf16_f32 v128, v128, v128
    v_lshlrev_b32 v128, 16, v128
    s_lshl_b32 s72, s93, 7
    s_add_u32 s72, s72, 16777216
    v_lshlrev_b32 v248, 2, v254
    s_mov_b32 exec_hi, 0
    buffer_store_dword v128, v248, s[44:47], s72 offen sc1
    s_mov_b64 exec, -1
.Lattn:
    s_lshl_b32 s72, s3, 11
    s_add_u32 s72, s72, 32768
    v_add_u32 v241, s72, v247
    v_and_b32 v2, 15, v254
    v_lshrrev_b32 v3, 5, v254
    v_lshl_add_u32 v2, v3, 4, v2
    v_lshlrev_b32 v2, 4, v2
    v_add_u32 v240, s72, v2
    v_mov_b32 v48, 0x3f803f80
    v_mov_b32 v49, 0x3f803f80
    v_mov_b32 v50, 0x3f803f80
    v_mov_b32 v51, 0x3f803f80
    v_mov_b32 v52, 0x3f803f80
    v_mov_b32 v53, 0x3f803f80
    v_mov_b32 v54, 0x3f803f80
    v_mov_b32 v55, 0x3f803f80
    v_mov_b32 v56, 0x3f803f80
    v_mov_b32 v57, 0x3f803f80
    v_mov_b32 v58, 0x3f803f80
    v_mov_b32 v59, 0x3f803f80
    v_mov_b32 v60, 0x3f803f80
    v_mov_b32 v61, 0x3f803f80
    v_mov_b32 v62, 0x3f803f80
    v_mov_b32 v63, 0x3f803f80
    v_and_b32 v2, 31, v254
    v_lshlrev_b32 v3, 2, v3
    v_sub_u32 v242, v2, v3
    v_mov_b32 v243, 4286578688
    v_cmp_le_i32 vcc, 0, v242
    s_nop 1
    v_cndmask_b32 v96, v243, 0, vcc
    v_cndmask_b32 v112, 0, v243, vcc
    v_cmp_le_i32 vcc, 1, v242
    s_nop 1
    v_cndmask_b32 v97, v243, 0, vcc
    v_cndmask_b32 v113, 0, v243, vcc
    v_cmp_le_i32 vcc, 2, v242
    s_nop 1
    v_cndmask_b32 v98, v243, 0, vcc
    v_cndmask_b32 v114, 0, v243, vcc
    v_cmp_le_i32 vcc, 3, v242
    s_nop 1
    v_cndmask_b32 v99, v243, 0, vcc
    v_cndmask_b32 v115, 0, v243, vcc
    v_cmp_le_i32 vcc, 8, v242
    s_nop 1
    v_cndmask_b32 v100, v243, 0, vcc
    v_cndmask_b32 v116, 0, v243, vcc
    v_cmp_le_i32 vcc, 9, v242
    s_nop 1
    v_cndmask_b32 v101, v243, 0, vcc
    v_cndmask_b32 v117, 0, v243, vcc
    v_cmp_le_i32 vcc, 10, v242
    s_nop 1
    v_cndmask_b32 v102, v243, 0, vcc
    v_cndmask_b32 v118, 0, v243, vcc
    v_cmp_le_i32 vcc, 11, v242
    s_nop 1
    v_cndmask_b32 v103, v243, 0, vcc
    v_cndmask_b32 v119, 0, v243, vcc
    v_cmp_le_i32 vcc, 16, v242
    s_nop 1
    v_cndmask_b32 v104, v243, 0, vcc
    v_cndmask_b32 v120, 0, v243, vcc
    v_cmp_le_i32 vcc, 17, v242
    s_nop 1
    v_cndmask_b32 v105, v243, 0, vcc
    v_cndmask_b32 v121, 0, v243, vcc
    v_cmp_le_i32 vcc, 18, v242
    s_nop 1
    v_cndmask_b32 v106, v243, 0, vcc
    v_cndmask_b32 v122, 0, v243, vcc
    v_cmp_le_i32 vcc, 19, v242
    s_nop 1
    v_cndmask_b32 v107, v243, 0, vcc
    v_cndmask_b32 v123, 0, v243, vcc
    v_cmp_le_i32 vcc, 24, v242
    s_nop 1
    v_cndmask_b32 v108, v243, 0, vcc
    v_cndmask_b32 v124, 0, v243, vcc
    v_cmp_le_i32 vcc, 25, v242
    s_nop 1
    v_cndmask_b32 v109, v243, 0, vcc
    v_cndmask_b32 v125, 0, v243, vcc
    v_cmp_le_i32 vcc, 26, v242
    s_nop 1
    v_cndmask_b32 v110, v243, 0, vcc
    v_cndmask_b32 v126, 0, v243, vcc
    v_cmp_le_i32 vcc, 27, v242
    s_nop 1
    v_cndmask_b32 v111, v243, 0, vcc
    v_cndmask_b32 v127, 0, v243, vcc
    v_mov_b32 v160, 4286578688
    v_mov_b32 v161, 4286578688
    v_mov_b32 v162, 4286578688
    v_mov_b32 v163, 4286578688
    s_lshl_b32 s15, s3, 1
    s_sub_u32 s15, 8, s15
    s_cmp_eq_u32 s9, 0
    s_cselect_b32 s15, s15, 0
    s_lshl_b32 s76, s6, 2
    s_add_u32 s76, s76, s3
    s_lshl_b32 s76, s76, 4
    s_add_u32 s76, s76, s7
    s_lshl_b32 s76, s76, 2
    s_add_u32 s76, s76, 16850944
    v_mov_b32 v242, 155672
    v_mov_b32 v243, 1
    s_mov_b64 exec, 1
    ds_add_u32 v242, v243
    s_mov_b64 exec, -1
    s_mov_b32 s77, 0
    s_mov_b32 s74, 262144
.Lstg_cw:
    v_mov_b32 v242, 155668
    ds_read_b32 v243, v242
    s_waitcnt lgkmcnt(0)
    v_readfirstlane_b32 s72, v243
    s_cmp_eq_u32 s72, 4
    s_cbranch_scc1 .Lstg_cok
    s_cmp_lg_u32 s77, 0
    s_cbranch_scc1 .Lstg_np
    s_getreg_b32 s72, hwreg(HW_REG_IB_STS)
    s_and_b32 s72, s72, 0xc0000f
    s_cmp_lg_u32 s72, 0
    s_cbranch_scc1 .Lstg_np
    s_waitcnt vmcnt(0)
    s_mov_b64 exec, 1
    v_mov_b32 v242, 0
    v_mov_b32 v243, s13
    buffer_store_dword v243, v242, s[44:47], s76 offen sc1
    s_mov_b64 exec, -1
    s_mov_b32 s77, 1
.Lstg_np:
    s_sleep 1
    s_sub_u32 s74, s74, 1
    s_cmp_lg_u32 s74, 0
    s_cbranch_scc1 .Lstg_cw
.Lstg_cok:
    ds_read_b128 v[44:47], v241 offset:33792
    ds_read_b128 v[36:39], v241 offset:9216
    ds_read_b128 v[40:43], v241 offset:32768
    ds_read_b128 v[32:35], v241 offset:8192
    ds_read_b128 v[28:31], v241 offset:7168
    ds_read_b128 v[24:27], v241 offset:6144
    ds_read_b128 v[20:23], v241 offset:5120
    ds_read_b128 v[16:19], v241 offset:4096
    ds_read_b128 v[12:15], v241 offset:3072
    ds_read_b128 v[8:11], v241 offset:2048
    ds_read_b128 v[4:7], v241 offset:1024
    ds_read_b128 v[0:3], v241 offset:0
    s_waitcnt lgkmcnt(8)
    v_mfma_f32_32x32x16_bf16 v[80:95], v[36:39], v[44:47], v[96:111]
    s_waitcnt lgkmcnt(0)
    s_nop 7
    v_mfma_f32_32x32x16_bf16 v[64:79], v[32:35], v[40:43], v[96:111]
    s_nop 2
    v_max3_f32 v162, v80, v81, v162
    v_max3_f32 v163, v82, v83, v163
    v_max3_f32 v162, v84, v85, v162
    v_max3_f32 v163, v86, v87, v163
    v_max3_f32 v162, v88, v89, v162
    v_max3_f32 v163, v90, v91, v163
    v_max3_f32 v162, v92, v93, v162
    v_max3_f32 v163, v94, v95, v163
    v_mfma_f32_32x32x16_bf16 v[80:95], v[32:35], v[44:47], 0
    s_nop 2
    v_max3_f32 v160, v64, v65, v160
    v_max3_f32 v161, v66, v67, v161
    v_max3_f32 v160, v68, v69, v160
    v_max3_f32 v161, v70, v71, v161
    v_max3_f32 v160, v72, v73, v160
    v_max3_f32 v161, v74, v75, v161
    v_max3_f32 v160, v76, v77, v160
    v_max3_f32 v161, v78, v79, v161
    v_mfma_f32_32x32x16_bf16 v[64:79], v[28:31], v[40:43], 0
    s_nop 2
    v_max3_f32 v162, v80, v81, v162
    v_max3_f32 v163, v82, v83, v163
    v_max3_f32 v162, v84, v85, v162
    v_max3_f32 v163, v86, v87, v163
    v_max3_f32 v162, v88, v89, v162
    v_max3_f32 v163, v90, v91, v163
    v_max3_f32 v162, v92, v93, v162
    v_max3_f32 v163, v94, v95, v163
    s_cmp_eq_u32 s15, 8
    s_cbranch_scc1 .Lp1done
    v_mfma_f32_32x32x16_bf16 v[80:95], v[28:31], v[44:47], 0
    s_nop 2
    v_max3_f32 v160, v64, v65, v160
    v_max3_f32 v161, v66, v67, v161
    v_max3_f32 v160, v68, v69, v160
    v_max3_f32 v161, v70, v71, v161
    v_max3_f32 v160, v72, v73, v160
    v_max3_f32 v161, v74, v75, v161
    v_max3_f32 v160, v76, v77, v160
    v_max3_f32 v161, v78, v79, v161
    v_mfma_f32_32x32x16_bf16 v[64:79], v[24:27], v[40:43], 0
    s_nop 2
    v_max3_f32 v162, v80, v81, v162
    v_max3_f32 v163, v82, v83, v163
    v_max3_f32 v162, v84, v85, v162
    v_max3_f32 v163, v86, v87, v163
    v_max3_f32 v162, v88, v89, v162
    v_max3_f32 v163, v90, v91, v163
    v_max3_f32 v162, v92, v93, v162
    v_max3_f32 v163, v94, v95, v163
    v_mfma_f32_32x32x16_bf16 v[80:95], v[24:27], v[44:47], 0
    s_nop 2
    v_max3_f32 v160, v64, v65, v160
    v_max3_f32 v161, v66, v67, v161
    v_max3_f32 v160, v68, v69, v160
    v_max3_f32 v161, v70, v71, v161
    v_max3_f32 v160, v72, v73, v160
    v_max3_f32 v161, v74, v75, v161
    v_max3_f32 v160, v76, v77, v160
    v_max3_f32 v161, v78, v79, v161
    v_mfma_f32_32x32x16_bf16 v[64:79], v[20:23], v[40:43], 0
    s_nop 2
    v_max3_f32 v162, v80, v81, v162
    v_max3_f32 v163, v82, v83, v163
    v_max3_f32 v162, v84, v85, v162
    v_max3_f32 v163, v86, v87, v163
    v_max3_f32 v162, v88, v89, v162
    v_max3_f32 v163, v90, v91, v163
    v_max3_f32 v162, v92, v93, v162
    v_max3_f32 v163, v94, v95, v163
    s_cmp_eq_u32 s15, 6
    s_cbranch_scc1 .Lp1done
    v_mfma_f32_32x32x16_bf16 v[80:95], v[20:23], v[44:47], 0
    s_nop 2
    v_max3_f32 v160, v64, v65, v160
    v_max3_f32 v161, v66, v67, v161
    v_max3_f32 v160, v68, v69, v160
    v_max3_f32 v161, v70, v71, v161
    v_max3_f32 v160, v72, v73, v160
    v_max3_f32 v161, v74, v75, v161
    v_max3_f32 v160, v76, v77, v160
    v_max3_f32 v161, v78, v79, v161
    v_mfma_f32_32x32x16_bf16 v[64:79], v[16:19], v[40:43], 0
    s_nop 2
    v_max3_f32 v162, v80, v81, v162
    v_max3_f32 v163, v82, v83, v163
    v_max3_f32 v162, v84, v85, v162
    v_max3_f32 v163, v86, v87, v163
    v_max3_f32 v162, v88, v89, v162
    v_max3_f32 v163, v90, v91, v163
    v_max3_f32 v162, v92, v93, v162
    v_max3_f32 v163, v94, v95, v163
    v_mfma_f32_32x32x16_bf16 v[80:95], v[16:19], v[44:47], 0
    s_nop 2
    v_max3_f32 v160, v64, v65, v160
    v_max3_f32 v161, v66, v67, v161
    v_max3_f32 v160, v68, v69, v160
    v_max3_f32 v161, v70, v71, v161
    v_max3_f32 v160, v72, v73, v160
    v_max3_f32 v161, v74, v75, v161
    v_max3_f32 v160, v76, v77, v160
    v_max3_f32 v161, v78, v79, v161
    v_mfma_f32_32x32x16_bf16 v[64:79], v[12:15], v[40:43], 0
    s_nop 2
    v_max3_f32 v162, v80, v81, v162
    v_max3_f32 v163, v82, v83, v163
    v_max3_f32 v162, v84, v85, v162
    v_max3_f32 v163, v86, v87, v163
    v_max3_f32 v162, v88, v89, v162
    v_max3_f32 v163, v90, v91, v163
    v_max3_f32 v162, v92, v93, v162
    v_max3_f32 v163, v94, v95, v163
    s_cmp_eq_u32 s15, 4
    s_cbranch_scc1 .Lp1done
    v_mfma_f32_32x32x16_bf16 v[80:95], v[12:15], v[44:47], 0
    s_nop 2
    v_max3_f32 v160, v64, v65, v160
    v_max3_f32 v161, v66, v67, v161
    v_max3_f32 v160, v68, v69, v160
    v_max3_f32 v161, v70, v71, v161
    v_max3_f32 v160, v72, v73, v160
    v_max3_f32 v161, v74, v75, v161
    v_max3_f32 v160, v76, v77, v160
    v_max3_f32 v161, v78, v79, v161
    v_mfma_f32_32x32x16_bf16 v[64:79], v[8:11], v[40:43], 0
    s_nop 2
    v_max3_f32 v162, v80, v81, v162
    v_max3_f32 v163, v82, v83, v163
    v_max3_f32 v162, v84, v85, v162
    v_max3_f32 v163, v86, v87, v163
    v_max3_f32 v162, v88, v89, v162
    v_max3_f32 v163, v90, v91, v163
    v_max3_f32 v162, v92, v93, v162
    v_max3_f32 v163, v94, v95, v163
    v_mfma_f32_32x32x16_bf16 v[80:95], v[8:11], v[44:47], 0
    s_nop 2
    v_max3_f32 v160, v64, v65, v160
    v_max3_f32 v161, v66, v67, v161
    v_max3_f32 v160, v68, v69, v160
    v_max3_f32 v161, v70, v71, v161
    v_max3_f32 v160, v72, v73, v160
    v_max3_f32 v161, v74, v75, v161
    v_max3_f32 v160, v76, v77, v160
    v_max3_f32 v161, v78, v79, v161
    v_mfma_f32_32x32x16_bf16 v[64:79], v[4:7], v[40:43], 0
    s_nop 2
    v_max3_f32 v162, v80, v81, v162
    v_max3_f32 v163, v82, v83, v163
    v_max3_f32 v162, v84, v85, v162
    v_max3_f32 v163, v86, v87, v163
    v_max3_f32 v162, v88, v89, v162
    v_max3_f32 v163, v90, v91, v163
    v_max3_f32 v162, v92, v93, v162
    v_max3_f32 v163, v94, v95, v163
    s_cmp_eq_u32 s15, 2
    s_cbranch_scc1 .Lp1done
    v_mfma_f32_32x32x16_bf16 v[80:95], v[4:7], v[44:47], v[112:127]
    s_nop 2
    v_max3_f32 v160, v64, v65, v160
    v_max3_f32 v161, v66, v67, v161
    v_max3_f32 v160, v68, v69, v160
    v_max3_f32 v161, v70, v71, v161
    v_max3_f32 v160, v72, v73, v160
    v_max3_f32 v161, v74, v75, v161
    v_max3_f32 v160, v76, v77, v160
    v_max3_f32 v161, v78, v79, v161
    v_mfma_f32_32x32x16_bf16 v[64:79], v[0:3], v[40:43], v[112:127]
    s_nop 2
    v_max3_f32 v162, v80, v81, v162
    v_max3_f32 v163, v82, v83, v163
    v_max3_f32 v162, v84, v85, v162
    v_max3_f32 v163, v86, v87, v163
    v_max3_f32 v162, v88, v89, v162
    v_max3_f32 v163, v90, v91, v163
    v_max3_f32 v162, v92, v93, v162
    v_max3_f32 v163, v94, v95, v163
    s_nop 2
    v_max3_f32 v160, v64, v65, v160
    v_max3_f32 v161, v66, v67, v161
    v_max3_f32 v160, v68, v69, v160
    v_max3_f32 v161, v70, v71, v161
    v_max3_f32 v160, v72, v73, v160
    v_max3_f32 v161, v74, v75, v161
    v_max3_f32 v160, v76, v77, v160
    v_max3_f32 v161, v78, v79, v161
.Lp1done:
    s_mov_b32 exec_lo, 0xffff
    s_mov_b32 exec_hi, 0xffff
    ds_read_b128 v[56:59], v240 offset:25600
    ds_read_b128 v[60:63], v240 offset:26112
    s_mov_b64 exec, -1
    s_mov_b32 exec_lo, 0xffff
    s_mov_b32 exec_hi, 0xffff
    ds_read_b128 v[48:51], v240 offset:24576
    ds_read_b128 v[52:55], v240 offset:25088
    s_mov_b64 exec, -1
    v_max_f32 v160, v160, v161
    v_mov_b32 v161, v160
    v_max_f32 v162, v162, v163
    v_mov_b32 v163, v162
    s_nop 1
    v_permlane32_swap_b32 v160, v161
    v_permlane32_swap_b32 v162, v163
    s_nop 1
    v_max_f32 v160, v160, v161
    v_max_f32 v162, v162, v163
    v_sub_f32 v192, 0, v162
    v_sub_f32 v193, 0, v162
    v_sub_f32 v194, 0, v162
    v_sub_f32 v195, 0, v162
    v_sub_f32 v196, 0, v162
    v_sub_f32 v197, 0, v162
    v_sub_f32 v198, 0, v162
    v_sub_f32 v199, 0, v162
    v_sub_f32 v200, 0, v162
    v_sub_f32 v201, 0, v162
    v_sub_f32 v202, 0, v162
    v_sub_f32 v203, 0, v162
    v_sub_f32 v204, 0, v162
    v_sub_f32 v205, 0, v162
    v_sub_f32 v206, 0, v162
    v_sub_f32 v207, 0, v162
    v_sub_f32 v176, 0, v160
    v_sub_f32 v177, 0, v160
    v_sub_f32 v178, 0, v160
    v_sub_f32 v179, 0, v160
    v_sub_f32 v180, 0, v160
    v_sub_f32 v181, 0, v160
    v_sub_f32 v182, 0, v160
    v_sub_f32 v183, 0, v160
    v_sub_f32 v184, 0, v160
    v_sub_f32 v185, 0, v160
    v_sub_f32 v186, 0, v160
    v_sub_f32 v187, 0, v160
    v_sub_f32 v188, 0, v160
    v_sub_f32 v189, 0, v160
    v_sub_f32 v190, 0, v160
    v_sub_f32 v191, 0, v160
    s_cmp_lg_u32 s77, 0
    s_cbranch_scc1 .Lfbdone
    s_waitcnt vmcnt(0)
    s_mov_b64 exec, 1
    v_mov_b32 v242, 0
    v_mov_b32 v243, s13
    buffer_store_dword v243, v242, s[44:47], s76 offen sc1
    s_mov_b64 exec, -1
.Lfbdone:
    s_nop 1
    v_mfma_f32_32x32x16_bf16 v[80:95], v[36:39], v[44:47], v[192:207]
    s_nop 11
    v_mfma_f32_32x32x16_bf16 v[64:79], v[32:35], v[40:43], v[176:191]
    v_add_f32 v80, v80, v96
    v_add_f32 v81, v81, v97
    v_add_f32 v82, v82, v98
    v_add_f32 v83, v83, v99
    v_add_f32 v84, v84, v100
    v_add_f32 v85, v85, v101
    v_add_f32 v86, v86, v102
    v_add_f32 v87, v87, v103
    v_add_f32 v88, v88, v104
    v_add_f32 v89, v89, v105
    v_add_f32 v90, v90, v106
    v_add_f32 v91, v91, v107
    v_add_f32 v92, v92, v108
    v_add_f32 v93, v93, v109
    v_add_f32 v94, v94, v110
    v_add_f32 v95, v95, v111
    v_exp_f32 v80, v80
    v_exp_f32 v81, v81
    v_exp_f32 v82, v82
    v_exp_f32 v83, v83
    v_exp_f32 v84, v84
    v_exp_f32 v85, v85
    v_exp_f32 v86, v86
    v_exp_f32 v87, v87
    v_exp_f32 v88, v88
    v_exp_f32 v89, v89
    v_exp_f32 v90, v90
    v_exp_f32 v91, v91
    v_exp_f32 v92, v92
    v_exp_f32 v93, v93
    v_exp_f32 v94, v94
    v_exp_f32 v95, v95
    s_nop 0
    v_cvt_pk_bf16_f32 v216, v80, v81
    v_cvt_pk_bf16_f32 v217, v82, v83
    v_cvt_pk_bf16_f32 v218, v84, v85
    v_cvt_pk_bf16_f32 v219, v86, v87
    v_cvt_pk_bf16_f32 v220, v88, v89
    v_cvt_pk_bf16_f32 v221, v90, v91
    v_cvt_pk_bf16_f32 v222, v92, v93
    v_cvt_pk_bf16_f32 v223, v94, v95
    v_mfma_f32_32x32x16_bf16 v[80:95], v[32:35], v[44:47], v[192:207]
    v_add_f32 v64, v64, v96
    v_add_f32 v65, v65, v97
    v_add_f32 v66, v66, v98
    v_add_f32 v67, v67, v99
    v_add_f32 v68, v68, v100
    v_add_f32 v69, v69, v101
    v_add_f32 v70, v70, v102
    v_add_f32 v71, v71, v103
    v_add_f32 v72, v72, v104
    v_add_f32 v73, v73, v105
    v_add_f32 v74, v74, v106
    v_add_f32 v75, v75, v107
    v_add_f32 v76, v76, v108
    v_add_f32 v77, v77, v109
    v_add_f32 v78, v78, v110
    v_add_f32 v79, v79, v111
    v_exp_f32 v64, v64
    v_exp_f32 v65, v65
    v_exp_f32 v66, v66
    v_exp_f32 v67, v67
    s_waitcnt lgkmcnt(0)
    v_mfma_f32_32x32x16_bf16 v[144:159], v[56:59], v[216:219], 0
    v_exp_f32 v68, v68
    v_exp_f32 v69, v69
    v_exp_f32 v70, v70
    v_exp_f32 v71, v71
    v_exp_f32 v72, v72
    v_mfma_f32_32x32x16_bf16 v[144:159], v[60:63], v[220:223], v[144:159]
    s_mov_b32 exec_lo, 0xffff
    s_mov_b32 exec_hi, 0xffff
    ds_read_b128 v[56:59], v240 offset:23552
    ds_read_b128 v[60:63], v240 offset:24064
    s_mov_b64 exec, -1
    v_exp_f32 v73, v73
    v_exp_f32 v74, v74
    v_exp_f32 v75, v75
    v_exp_f32 v76, v76
    v_exp_f32 v77, v77
    v_exp_f32 v78, v78
    v_exp_f32 v79, v79
    s_nop 0
    v_cvt_pk_bf16_f32 v208, v64, v65
    v_cvt_pk_bf16_f32 v209, v66, v67
    v_cvt_pk_bf16_f32 v210, v68, v69
    v_cvt_pk_bf16_f32 v211, v70, v71
    v_cvt_pk_bf16_f32 v212, v72, v73
    v_cvt_pk_bf16_f32 v213, v74, v75
    v_cvt_pk_bf16_f32 v214, v76, v77
    v_cvt_pk_bf16_f32 v215, v78, v79
    v_mfma_f32_32x32x16_bf16 v[64:79], v[28:31], v[40:43], v[176:191]
    v_exp_f32 v80, v80
    v_exp_f32 v81, v81
    v_exp_f32 v82, v82
    v_exp_f32 v83, v83
    s_waitcnt lgkmcnt(0)
    v_mfma_f32_32x32x16_bf16 v[128:143], v[48:51], v[208:211], 0
    v_exp_f32 v84, v84
    v_exp_f32 v85, v85
    v_exp_f32 v86, v86
    v_exp_f32 v87, v87
    v_exp_f32 v88, v88
    v_mfma_f32_32x32x16_bf16 v[128:143], v[52:55], v[212:215], v[128:143]
    v_exp_f32 v89, v89
    v_exp_f32 v90, v90
    v_exp_f32 v91, v91
    v_exp_f32 v92, v92
    v_exp_f32 v93, v93
    v_exp_f32 v94, v94
    v_exp_f32 v95, v95
    s_nop 0
    v_cvt_pk_bf16_f32 v216, v80, v81
    v_cvt_pk_bf16_f32 v217, v82, v83
    v_cvt_pk_bf16_f32 v218, v84, v85
    v_cvt_pk_bf16_f32 v219, v86, v87
    v_cvt_pk_bf16_f32 v220, v88, v89
    v_cvt_pk_bf16_f32 v221, v90, v91
    v_cvt_pk_bf16_f32 v222, v92, v93
    v_cvt_pk_bf16_f32 v223, v94, v95
    s_cmp_eq_u32 s15, 8
    s_cbranch_scc1 .Lp2x8
    v_mfma_f32_32x32x16_bf16 v[80:95], v[28:31], v[44:47], v[192:207]
    v_exp_f32 v64, v64
    v_exp_f32 v65, v65
    v_exp_f32 v66, v66
    v_exp_f32 v67, v67
    v_mfma_f32_32x32x16_bf16 v[144:159], v[48:51], v[216:219], v[144:159]
    v_exp_f32 v68, v68
    v_exp_f32 v69, v69
    v_exp_f32 v70, v70
    v_exp_f32 v71, v71
    v_exp_f32 v72, v72
    v_mfma_f32_32x32x16_bf16 v[144:159], v[52:55], v[220:223], v[144:159]
    s_mov_b32 exec_lo, 0xffff
    s_mov_b32 exec_hi, 0xffff
    ds_read_b128 v[48:51], v240 offset:22528
    ds_read_b128 v[52:55], v240 offset:23040
    s_mov_b64 exec, -1
    v_exp_f32 v73, v73
    v_exp_f32 v74, v74
    v_exp_f32 v75, v75
    v_exp_f32 v76, v76
    v_exp_f32 v77, v77
    v_exp_f32 v78, v78
    v_exp_f32 v79, v79
    s_nop 0
    v_cvt_pk_bf16_f32 v208, v64, v65
    v_cvt_pk_bf16_f32 v209, v66, v67
    v_cvt_pk_bf16_f32 v210, v68, v69
    v_cvt_pk_bf16_f32 v211, v70, v71
    v_cvt_pk_bf16_f32 v212, v72, v73
    v_cvt_pk_bf16_f32 v213, v74, v75
    v_cvt_pk_bf16_f32 v214, v76, v77
    v_cvt_pk_bf16_f32 v215, v78, v79
    v_mfma_f32_32x32x16_bf16 v[64:79], v[24:27], v[40:43], v[176:191]
    v_exp_f32 v80, v80
    v_exp_f32 v81, v81
    v_exp_f32 v82, v82
    v_exp_f32 v83, v83
    s_waitcnt lgkmcnt(0)
    v_mfma_f32_32x32x16_bf16 v[128:143], v[56:59], v[208:211], v[128:143]
    v_exp_f32 v84, v84
    v_exp_f32 v85, v85
    v_exp_f32 v86, v86
    v_exp_f32 v87, v87
    v_exp_f32 v88, v88
    v_mfma_f32_32x32x16_bf16 v[128:143], v[60:63], v[212:215], v[128:143]
    v_exp_f32 v89, v89
    v_exp_f32 v90, v90
    v_exp_f32 v91, v91
    v_exp_f32 v92, v92
    v_exp_f32 v93, v93
    v_exp_f32 v94, v94
    v_exp_f32 v95, v95
    s_nop 0
    v_cvt_pk_bf16_f32 v216, v80, v81
    v_cvt_pk_bf16_f32 v217, v82, v83
    v_cvt_pk_bf16_f32 v218, v84, v85
    v_cvt_pk_bf16_f32 v219, v86, v87
    v_cvt_pk_bf16_f32 v220, v88, v89
    v_cvt_pk_bf16_f32 v221, v90, v91
    v_cvt_pk_bf16_f32 v222, v92, v93
    v_cvt_pk_bf16_f32 v223, v94, v95
    v_mfma_f32_32x32x16_bf16 v[80:95], v[24:27], v[44:47], v[192:207]
    v_exp_f32 v64, v64
    v_exp_f32 v65, v65
    v_exp_f32 v66, v66
    v_exp_f32 v67, v67
    v_mfma_f32_32x32x16_bf16 v[144:159], v[56:59], v[216:219], v[144:159]
    v_exp_f32 v68, v68
    v_exp_f32 v69, v69
    v_exp_f32 v70, v70
    v_exp_f32 v71, v71
    v_exp_f32 v72, v72
    v_mfma_f32_32x32x16_bf16 v[144:159], v[60:63], v[220:223], v[144:159]
    s_mov_b32 exec_lo, 0xffff
    s_mov_b32 exec_hi, 0xffff
    ds_read_b128 v[56:59], v240 offset:21504
    ds_read_b128 v[60:63], v240 offset:22016
    s_mov_b64 exec, -1
    v_exp_f32 v73, v73
    v_exp_f32 v74, v74
    v_exp_f32 v75, v75
    v_exp_f32 v76, v76
    v_exp_f32 v77, v77
    v_exp_f32 v78, v78
    v_exp_f32 v79, v79
    s_nop 0
    v_cvt_pk_bf16_f32 v208, v64, v65
    v_cvt_pk_bf16_f32 v209, v66, v67
    v_cvt_pk_bf16_f32 v210, v68, v69
    v_cvt_pk_bf16_f32 v211, v70, v71
    v_cvt_pk_bf16_f32 v212, v72, v73
    v_cvt_pk_bf16_f32 v213, v74, v75
    v_cvt_pk_bf16_f32 v214, v76, v77
    v_cvt_pk_bf16_f32 v215, v78, v79
    v_mfma_f32_32x32x16_bf16 v[64:79], v[20:23], v[40:43], v[176:191]
    v_exp_f32 v80, v80
    v_exp_f32 v81, v81
    v_exp_f32 v82, v82
    v_exp_f32 v83, v83
    s_waitcnt lgkmcnt(0)
    v_mfma_f32_32x32x16_bf16 v[128:143], v[48:51], v[208:211], v[128:143]
    v_exp_f32 v84, v84
    v_exp_f32 v85, v85
    v_exp_f32 v86, v86
    v_exp_f32 v87, v87
    v_exp_f32 v88, v88
    v_mfma_f32_32x32x16_bf16 v[128:143], v[52:55], v[212:215], v[128:143]
    v_exp_f32 v89, v89
    v_exp_f32 v90, v90
    v_exp_f32 v91, v91
    v_exp_f32 v92, v92
    v_exp_f32 v93, v93
    v_exp_f32 v94, v94
    v_exp_f32 v95, v95
    s_nop 0
    v_cvt_pk_bf16_f32 v216, v80, v81
    v_cvt_pk_bf16_f32 v217, v82, v83
    v_cvt_pk_bf16_f32 v218, v84, v85
    v_cvt_pk_bf16_f32 v219, v86, v87
    v_cvt_pk_bf16_f32 v220, v88, v89
    v_cvt_pk_bf16_f32 v221, v90, v91
    v_cvt_pk_bf16_f32 v222, v92, v93
    v_cvt_pk_bf16_f32 v223, v94, v95
    s_cmp_eq_u32 s15, 6
    s_cbranch_scc1 .Lp2x6
    v_mfma_f32_32x32x16_bf16 v[80:95], v[20:23], v[44:47], v[192:207]
    v_exp_f32 v64, v64
    v_exp_f32 v65, v65
    v_exp_f32 v66, v66
    v_exp_f32 v67, v67
    v_mfma_f32_32x32x16_bf16 v[144:159], v[48:51], v[216:219], v[144:159]
    v_exp_f32 v68, v68
    v_exp_f32 v69, v69
    v_exp_f32 v70, v70
    v_exp_f32 v71, v71
    v_exp_f32 v72, v72
    v_mfma_f32_32x32x16_bf16 v[144:159], v[52:55], v[220:223], v[144:159]
    s_mov_b32 exec_lo, 0xffff
    s_mov_b32 exec_hi, 0xffff
    ds_read_b128 v[48:51], v240 offset:20480
    ds_read_b128 v[52:55], v240 offset:20992
    s_mov_b64 exec, -1
    v_exp_f32 v73, v73
    v_exp_f32 v74, v74
    v_exp_f32 v75, v75
    v_exp_f32 v76, v76
    v_exp_f32 v77, v77
    v_exp_f32 v78, v78
    v_exp_f32 v79, v79
    s_nop 0
    v_cvt_pk_bf16_f32 v208, v64, v65
    v_cvt_pk_bf16_f32 v209, v66, v67
    v_cvt_pk_bf16_f32 v210, v68, v69
    v_cvt_pk_bf16_f32 v211, v70, v71
    v_cvt_pk_bf16_f32 v212, v72, v73
    v_cvt_pk_bf16_f32 v213, v74, v75
    v_cvt_pk_bf16_f32 v214, v76, v77
    v_cvt_pk_bf16_f32 v215, v78, v79
    v_mfma_f32_32x32x16_bf16 v[64:79], v[16:19], v[40:43], v[176:191]
    v_exp_f32 v80, v80
    v_exp_f32 v81, v81
    v_exp_f32 v82, v82
    v_exp_f32 v83, v83
    s_waitcnt lgkmcnt(0)
    v_mfma_f32_32x32x16_bf16 v[128:143], v[56:59], v[208:211], v[128:143]
    v_exp_f32 v84, v84
    v_exp_f32 v85, v85
    v_exp_f32 v86, v86
    v_exp_f32 v87, v87
    v_exp_f32 v88, v88
    v_mfma_f32_32x32x16_bf16 v[128:143], v[60:63], v[212:215], v[128:143]
    v_exp_f32 v89, v89
    v_exp_f32 v90, v90
    v_exp_f32 v91, v91
    v_exp_f32 v92, v92
    v_exp_f32 v93, v93
    v_exp_f32 v94, v94
    v_exp_f32 v95, v95
    s_nop 0
    v_cvt_pk_bf16_f32 v216, v80, v81
    v_cvt_pk_bf16_f32 v217, v82, v83
    v_cvt_pk_bf16_f32 v218, v84, v85
    v_cvt_pk_bf16_f32 v219, v86, v87
    v_cvt_pk_bf16_f32 v220, v88, v89
    v_cvt_pk_bf16_f32 v221, v90, v91
    v_cvt_pk_bf16_f32 v222, v92, v93
    v_cvt_pk_bf16_f32 v223, v94, v95
    v_mfma_f32_32x32x16_bf16 v[80:95], v[16:19], v[44:47], v[192:207]
    v_exp_f32 v64, v64
    v_exp_f32 v65, v65
    v_exp_f32 v66, v66
    v_exp_f32 v67, v67
    v_mfma_f32_32x32x16_bf16 v[144:159], v[56:59], v[216:219], v[144:159]
    v_exp_f32 v68, v68
    v_exp_f32 v69, v69
    v_exp_f32 v70, v70
    v_exp_f32 v71, v71
    v_exp_f32 v72, v72
    v_mfma_f32_32x32x16_bf16 v[144:159], v[60:63], v[220:223], v[144:159]
    s_mov_b32 exec_lo, 0xffff
    s_mov_b32 exec_hi, 0xffff
    ds_read_b128 v[56:59], v240 offset:19456
    ds_read_b128 v[60:63], v240 offset:19968
    s_mov_b64 exec, -1
    v_exp_f32 v73, v73
    v_exp_f32 v74, v74
    v_exp_f32 v75, v75
    v_exp_f32 v76, v76
    v_exp_f32 v77, v77
    v_exp_f32 v78, v78
    v_exp_f32 v79, v79
    s_nop 0
    v_cvt_pk_bf16_f32 v208, v64, v65
    v_cvt_pk_bf16_f32 v209, v66, v67
    v_cvt_pk_bf16_f32 v210, v68, v69
    v_cvt_pk_bf16_f32 v211, v70, v71
    v_cvt_pk_bf16_f32 v212, v72, v73
    v_cvt_pk_bf16_f32 v213, v74, v75
    v_cvt_pk_bf16_f32 v214, v76, v77
    v_cvt_pk_bf16_f32 v215, v78, v79
    v_mfma_f32_32x32x16_bf16 v[64:79], v[12:15], v[40:43], v[176:191]
    v_exp_f32 v80, v80
    v_exp_f32 v81, v81
    v_exp_f32 v82, v82
    v_exp_f32 v83, v83
    s_waitcnt lgkmcnt(0)
    v_mfma_f32_32x32x16_bf16 v[128:143], v[48:51], v[208:211], v[128:143]
    v_exp_f32 v84, v84
    v_exp_f32 v85, v85
    v_exp_f32 v86, v86
    v_exp_f32 v87, v87
    v_exp_f32 v88, v88
    v_mfma_f32_32x32x16_bf16 v[128:143], v[52:55], v[212:215], v[128:143]
    v_exp_f32 v89, v89
    v_exp_f32 v90, v90
    v_exp_f32 v91, v91
    v_exp_f32 v92, v92
    v_exp_f32 v93, v93
    v_exp_f32 v94, v94
    v_exp_f32 v95, v95
    s_nop 0
    v_cvt_pk_bf16_f32 v216, v80, v81
    v_cvt_pk_bf16_f32 v217, v82, v83
    v_cvt_pk_bf16_f32 v218, v84, v85
    v_cvt_pk_bf16_f32 v219, v86, v87
    v_cvt_pk_bf16_f32 v220, v88, v89
    v_cvt_pk_bf16_f32 v221, v90, v91
    v_cvt_pk_bf16_f32 v222, v92, v93
    v_cvt_pk_bf16_f32 v223, v94, v95
    s_cmp_eq_u32 s15, 4
    s_cbranch_scc1 .Lp2x4
    v_mfma_f32_32x32x16_bf16 v[80:95], v[12:15], v[44:47], v[192:207]
    v_exp_f32 v64, v64
    v_exp_f32 v65, v65
    v_exp_f32 v66, v66
    v_exp_f32 v67, v67
    v_mfma_f32_32x32x16_bf16 v[144:159], v[48:51], v[216:219], v[144:159]
    v_exp_f32 v68, v68
    v_exp_f32 v69, v69
    v_exp_f32 v70, v70
    v_exp_f32 v71, v71
    v_exp_f32 v72, v72
    v_mfma_f32_32x32x16_bf16 v[144:159], v[52:55], v[220:223], v[144:159]
    s_mov_b32 exec_lo, 0xffff
    s_mov_b32 exec_hi, 0xffff
    ds_read_b128 v[48:51], v240 offset:18432
    ds_read_b128 v[52:55], v240 offset:18944
    s_mov_b64 exec, -1
    v_exp_f32 v73, v73
    v_exp_f32 v74, v74
    v_exp_f32 v75, v75
    v_exp_f32 v76, v76
    v_exp_f32 v77, v77
    v_exp_f32 v78, v78
    v_exp_f32 v79, v79
    s_nop 0
    v_cvt_pk_bf16_f32 v208, v64, v65
    v_cvt_pk_bf16_f32 v209, v66, v67
    v_cvt_pk_bf16_f32 v210, v68, v69
    v_cvt_pk_bf16_f32 v211, v70, v71
    v_cvt_pk_bf16_f32 v212, v72, v73
    v_cvt_pk_bf16_f32 v213, v74, v75
    v_cvt_pk_bf16_f32 v214, v76, v77
    v_cvt_pk_bf16_f32 v215, v78, v79
    v_mfma_f32_32x32x16_bf16 v[64:79], v[8:11], v[40:43], v[176:191]
    v_exp_f32 v80, v80
    v_exp_f32 v81, v81
    v_exp_f32 v82, v82
    v_exp_f32 v83, v83
    s_waitcnt lgkmcnt(0)
    v_mfma_f32_32x32x16_bf16 v[128:143], v[56:59], v[208:211], v[128:143]
    v_exp_f32 v84, v84
    v_exp_f32 v85, v85
    v_exp_f32 v86, v86
    v_exp_f32 v87, v87
    v_exp_f32 v88, v88
    v_mfma_f32_32x32x16_bf16 v[128:143], v[60:63], v[212:215], v[128:143]
    v_exp_f32 v89, v89
    v_exp_f32 v90, v90
    v_exp_f32 v91, v91
    v_exp_f32 v92, v92
    v_exp_f32 v93, v93
    v_exp_f32 v94, v94
    v_exp_f32 v95, v95
    s_nop 0
    v_cvt_pk_bf16_f32 v216, v80, v81
    v_cvt_pk_bf16_f32 v217, v82, v83
    v_cvt_pk_bf16_f32 v218, v84, v85
    v_cvt_pk_bf16_f32 v219, v86, v87
    v_cvt_pk_bf16_f32 v220, v88, v89
    v_cvt_pk_bf16_f32 v221, v90, v91
    v_cvt_pk_bf16_f32 v222, v92, v93
    v_cvt_pk_bf16_f32 v223, v94, v95
    v_mfma_f32_32x32x16_bf16 v[80:95], v[8:11], v[44:47], v[192:207]
    v_exp_f32 v64, v64
    v_exp_f32 v65, v65
    v_exp_f32 v66, v66
    v_exp_f32 v67, v67
    v_mfma_f32_32x32x16_bf16 v[144:159], v[56:59], v[216:219], v[144:159]
    v_exp_f32 v68, v68
    v_exp_f32 v69, v69
    v_exp_f32 v70, v70
    v_exp_f32 v71, v71
    v_exp_f32 v72, v72
    v_mfma_f32_32x32x16_bf16 v[144:159], v[60:63], v[220:223], v[144:159]
    s_mov_b32 exec_lo, 0xffff
    s_mov_b32 exec_hi, 0xffff
    ds_read_b128 v[56:59], v240 offset:17408
    ds_read_b128 v[60:63], v240 offset:17920
    s_mov_b64 exec, -1
    v_exp_f32 v73, v73
    v_exp_f32 v74, v74
    v_exp_f32 v75, v75
    v_exp_f32 v76, v76
    v_exp_f32 v77, v77
    v_exp_f32 v78, v78
    v_exp_f32 v79, v79
    s_nop 0
    v_cvt_pk_bf16_f32 v208, v64, v65
    v_cvt_pk_bf16_f32 v209, v66, v67
    v_cvt_pk_bf16_f32 v210, v68, v69
    v_cvt_pk_bf16_f32 v211, v70, v71
    v_cvt_pk_bf16_f32 v212, v72, v73
    v_cvt_pk_bf16_f32 v213, v74, v75
    v_cvt_pk_bf16_f32 v214, v76, v77
    v_cvt_pk_bf16_f32 v215, v78, v79
    v_mfma_f32_32x32x16_bf16 v[64:79], v[4:7], v[40:43], v[176:191]
    v_exp_f32 v80, v80
    v_exp_f32 v81, v81
    v_exp_f32 v82, v82
    v_exp_f32 v83, v83
    s_waitcnt lgkmcnt(0)
    v_mfma_f32_32x32x16_bf16 v[128:143], v[48:51], v[208:211], v[128:143]
    v_exp_f32 v84, v84
    v_exp_f32 v85, v85
    v_exp_f32 v86, v86
    v_exp_f32 v87, v87
    v_exp_f32 v88, v88
    v_mfma_f32_32x32x16_bf16 v[128:143], v[52:55], v[212:215], v[128:143]
    v_exp_f32 v89, v89
    v_exp_f32 v90, v90
    v_exp_f32 v91, v91
    v_exp_f32 v92, v92
    v_exp_f32 v93, v93
    v_exp_f32 v94, v94
    v_exp_f32 v95, v95
    s_nop 0
    v_cvt_pk_bf16_f32 v216, v80, v81
    v_cvt_pk_bf16_f32 v217, v82, v83
    v_cvt_pk_bf16_f32 v218, v84, v85
    v_cvt_pk_bf16_f32 v219, v86, v87
    v_cvt_pk_bf16_f32 v220, v88, v89
    v_cvt_pk_bf16_f32 v221, v90, v91
    v_cvt_pk_bf16_f32 v222, v92, v93
    v_cvt_pk_bf16_f32 v223, v94, v95
    s_cmp_eq_u32 s15, 2
    s_cbranch_scc1 .Lp2x2
    v_mfma_f32_32x32x16_bf16 v[80:95], v[4:7], v[44:47], v[192:207]
    v_exp_f32 v64, v64
    v_exp_f32 v65, v65
    v_exp_f32 v66, v66
    v_exp_f32 v67, v67
    v_mfma_f32_32x32x16_bf16 v[144:159], v[48:51], v[216:219], v[144:159]
    v_exp_f32 v68, v68
    v_exp_f32 v69, v69
    v_exp_f32 v70, v70
    v_exp_f32 v71, v71
    v_exp_f32 v72, v72
    v_mfma_f32_32x32x16_bf16 v[144:159], v[52:55], v[220:223], v[144:159]
    s_mov_b32 exec_lo, 0xffff
    s_mov_b32 exec_hi, 0xffff
    ds_read_b128 v[48:51], v240 offset:16384
    ds_read_b128 v[52:55], v240 offset:16896
    s_mov_b64 exec, -1
    v_exp_f32 v73, v73
    v_exp_f32 v74, v74
    v_exp_f32 v75, v75
    v_exp_f32 v76, v76
    v_exp_f32 v77, v77
    v_exp_f32 v78, v78
    v_exp_f32 v79, v79
    s_nop 0
    v_cvt_pk_bf16_f32 v208, v64, v65
    v_cvt_pk_bf16_f32 v209, v66, v67
    v_cvt_pk_bf16_f32 v210, v68, v69
    v_cvt_pk_bf16_f32 v211, v70, v71
    v_cvt_pk_bf16_f32 v212, v72, v73
    v_cvt_pk_bf16_f32 v213, v74, v75
    v_cvt_pk_bf16_f32 v214, v76, v77
    v_cvt_pk_bf16_f32 v215, v78, v79
    v_mfma_f32_32x32x16_bf16 v[64:79], v[0:3], v[40:43], v[176:191]
    v_add_f32 v80, v80, v112
    v_add_f32 v81, v81, v113
    v_add_f32 v82, v82, v114
    v_add_f32 v83, v83, v115
    v_add_f32 v84, v84, v116
    v_add_f32 v85, v85, v117
    v_add_f32 v86, v86, v118
    v_add_f32 v87, v87, v119
    v_add_f32 v88, v88, v120
    v_add_f32 v89, v89, v121
    v_add_f32 v90, v90, v122
    v_add_f32 v91, v91, v123
    v_add_f32 v92, v92, v124
    v_add_f32 v93, v93, v125
    v_add_f32 v94, v94, v126
    v_add_f32 v95, v95, v127
    v_exp_f32 v80, v80
    v_exp_f32 v81, v81
    v_exp_f32 v82, v82
    v_exp_f32 v83, v83
    s_waitcnt lgkmcnt(0)
    v_mfma_f32_32x32x16_bf16 v[128:143], v[56:59], v[208:211], v[128:143]
    v_exp_f32 v84, v84
    v_exp_f32 v85, v85
    v_exp_f32 v86, v86
    v_exp_f32 v87, v87
    v_exp_f32 v88, v88
    v_mfma_f32_32x32x16_bf16 v[128:143], v[60:63], v[212:215], v[128:143]
    v_exp_f32 v89, v89
    v_exp_f32 v90, v90
    v_exp_f32 v91, v91
    v_exp_f32 v92, v92
    v_exp_f32 v93, v93
    v_exp_f32 v94, v94
    v_exp_f32 v95, v95
    s_nop 0
    v_cvt_pk_bf16_f32 v216, v80, v81
    v_cvt_pk_bf16_f32 v217, v82, v83
    v_cvt_pk_bf16_f32 v218, v84, v85
    v_cvt_pk_bf16_f32 v219, v86, v87
    v_cvt_pk_bf16_f32 v220, v88, v89
    v_cvt_pk_bf16_f32 v221, v90, v91
    v_cvt_pk_bf16_f32 v222, v92, v93
    v_cvt_pk_bf16_f32 v223, v94, v95
    v_add_f32 v64, v64, v112
    v_add_f32 v65, v65, v113
    v_add_f32 v66, v66, v114
    v_add_f32 v67, v67, v115
    v_add_f32 v68, v68, v116
    v_add_f32 v69, v69, v117
    v_add_f32 v70, v70, v118
    v_add_f32 v71, v71, v119
    v_add_f32 v72, v72, v120
    v_add_f32 v73, v73, v121
    v_add_f32 v74, v74, v122
    v_add_f32 v75, v75, v123
    v_add_f32 v76, v76, v124
    v_add_f32 v77, v77, v125
    v_add_f32 v78, v78, v126
    v_add_f32 v79, v79, v127
    v_exp_f32 v64, v64
    v_exp_f32 v65, v65
    v_exp_f32 v66, v66
    v_exp_f32 v67, v67
    v_mfma_f32_32x32x16_bf16 v[144:159], v[56:59], v[216:219], v[144:159]
    v_exp_f32 v68, v68
    v_exp_f32 v69, v69
    v_exp_f32 v70, v70
    v_exp_f32 v71, v71
    v_exp_f32 v72, v72
    v_mfma_f32_32x32x16_bf16 v[144:159], v[60:63], v[220:223], v[144:159]
    v_exp_f32 v73, v73
    v_exp_f32 v74, v74
    v_exp_f32 v75, v75
    v_exp_f32 v76, v76
    v_exp_f32 v77, v77
    v_exp_f32 v78, v78
    v_exp_f32 v79, v79
    s_nop 0
    v_cvt_pk_bf16_f32 v208, v64, v65
    v_cvt_pk_bf16_f32 v209, v66, v67
    v_cvt_pk_bf16_f32 v210, v68, v69
    v_cvt_pk_bf16_f32 v211, v70, v71
    v_cvt_pk_bf16_f32 v212, v72, v73
    v_cvt_pk_bf16_f32 v213, v74, v75
    v_cvt_pk_bf16_f32 v214, v76, v77
    v_cvt_pk_bf16_f32 v215, v78, v79
    s_waitcnt lgkmcnt(0)
    v_mfma_f32_32x32x16_bf16 v[128:143], v[48:51], v[208:211], v[128:143]
    v_mfma_f32_32x32x16_bf16 v[128:143], v[52:55], v[212:215], v[128:143]
    s_branch .Lp2done
.Lp2x8:
    s_nop 0
    v_mfma_f32_32x32x16_bf16 v[144:159], v[48:51], v[216:219], v[144:159]
    v_mfma_f32_32x32x16_bf16 v[144:159], v[52:55], v[220:223], v[144:159]
    s_branch .Lp2done
.Lp2x6:
    s_nop 0
    v_mfma_f32_32x32x16_bf16 v[144:159], v[48:51], v[216:219], v[144:159]
    v_mfma_f32_32x32x16_bf16 v[144:159], v[52:55], v[220:223], v[144:159]
    s_branch .Lp2done
.Lp2x4:
    s_nop 0
    v_mfma_f32_32x32x16_bf16 v[144:159], v[48:51], v[216:219], v[144:159]
    v_mfma_f32_32x32x16_bf16 v[144:159], v[52:55], v[220:223], v[144:159]
    s_branch .Lp2done
.Lp2x2:
    s_nop 0
    v_mfma_f32_32x32x16_bf16 v[144:159], v[48:51], v[216:219], v[144:159]
    v_mfma_f32_32x32x16_bf16 v[144:159], v[52:55], v[220:223], v[144:159]
    s_branch .Lp2done
.Lp2done:
    s_lshl_b32 s72, s9, 3
    s_lshl_b32 s73, s3, 1
    s_add_u32 s72, s72, s73
    s_mul_i32 s72, s72, 118
    s_add_u32 s72, s72, s8
    s_lshl_b32 s72, s72, 10
    s_add_u32 s72, s72, 6379520
    s_add_u32 s73, s72, 120832
    s_waitcnt lgkmcnt(0)
    v_mov_b32 v242, 155652
    v_mov_b32 v243, 1
    s_mov_b64 exec, 1
    ds_add_u32 v242, v243
    s_mov_b64 exec, -1
    s_nop 7
    v_rcp_f32 v160, v152
    s_nop 0
    v_mul_f32 v144, v144, v160
    v_mul_f32 v145, v145, v160
    v_mul_f32 v146, v146, v160
    v_mul_f32 v147, v147, v160
    v_mul_f32 v148, v148, v160
    v_mul_f32 v149, v149, v160
    v_mul_f32 v150, v150, v160
    v_mul_f32 v151, v151, v160
    v_cvt_pk_bf16_f32 v144, v144, v145
    v_cvt_pk_bf16_f32 v145, v146, v147
    v_cvt_pk_bf16_f32 v146, v148, v149
    v_cvt_pk_bf16_f32 v147, v150, v151
    buffer_store_dwordx4 v[144:147], v247, s[44:47], s73 offen sc1
    v_rcp_f32 v160, v136
    s_nop 0
    v_mul_f32 v128, v128, v160
    v_mul_f32 v129, v129, v160
    v_mul_f32 v130, v130, v160
    v_mul_f32 v131, v131, v160
    v_mul_f32 v132, v132, v160
    v_mul_f32 v133, v133, v160
    v_mul_f32 v134, v134, v160
    v_mul_f32 v135, v135, v160
    v_cvt_pk_bf16_f32 v128, v128, v129
    v_cvt_pk_bf16_f32 v129, v130, v131
    v_cvt_pk_bf16_f32 v130, v132, v133
    v_cvt_pk_bf16_f32 v131, v134, v135
    buffer_store_dwordx4 v[128:131], v247, s[44:47], s72 offen sc1
    s_mul_i32 s72, s11, 236
    s_lshl_b32 s73, s3, 3
    s_add_u32 s72, s72, s73
    s_lshl_b32 s72, s72, 10
    s_add_u32 s72, s72, 14768128
    v_add_u32 v248, s72, v247
    v_add_u32 v249, 120832, v248
    s_mul_i32 s72, s10, 241664
    s_add_u32 s72, s72, 6291456
    s_add_u32 s76, s34, s72
    s_addc_u32 s77, s35, 0
    s_mov_b32 s78, 120832
    s_mov_b32 s79, 0x00020000
    s_add_u32 s72, s72, 120832
    s_add_u32 s80, s34, s72
    s_addc_u32 s81, s35, 0
    s_mov_b32 s82, 120832
    s_mov_b32 s83, 0x00020000
    s_add_u32 s72, s72, 120832
    s_lshl_b32 s91, s9, 2
    s_add_u32 s91, s91, s3
    s_lshl_b32 s91, s91, 5
    s_add_u32 s91, s91, s8
    s_lshl_b32 s91, s91, 2
    s_add_u32 s91, s91, 16855040
    v_mov_b32 v250, 0
    v_mov_b32 v251, s13
    s_waitcnt vmcnt(0)
    s_mov_b64 exec, 1
    buffer_store_dword v251, v250, s[44:47], s91 offen sc1
    s_mov_b64 exec, -1
    s_lshl_b32 s91, s11, 7
    s_lshl_b32 s72, s3, 3
    s_add_u32 s91, s91, s72
    s_lshl_b32 s91, s91, 2
    s_add_u32 s91, s91, 16863576
    s_mov_b32 s84, 0xff
    s_mov_b32 s85, 0
    v_lshlrev_b32 v250, 2, v254
    s_mov_b32 s74, 16384
.Lfwe_poll:
    buffer_load_dword v251, v250, s[44:47], s91 offen sc1
    s_waitcnt vmcnt(0)
    v_cmp_ne_u32 vcc, s13, v251
    s_and_b64 s[72:73], vcc, s[84:85]
    s_cbranch_scc0 .Lfwe_ok
    s_sleep 2
    s_sub_u32 s74, s74, 1
    s_cmp_lg_u32 s74, 0
    s_cbranch_scc1 .Lfwe_poll
.Lfwe_ok:
    buffer_load_dwordx4 v[0:3], v248, s[44:47], 0 offen offset:0
    buffer_load_dwordx4 v[4:7], v249, s[44:47], 0 offen offset:0
    buffer_load_dwordx4 v[8:11], v248, s[44:47], 0 offen offset:1024
    buffer_load_dwordx4 v[12:15], v249, s[44:47], 0 offen offset:1024
    buffer_load_dwordx4 v[16:19], v248, s[44:47], 0 offen offset:2048
    buffer_load_dwordx4 v[20:23], v249, s[44:47], 0 offen offset:2048
    buffer_load_dwordx4 v[24:27], v248, s[44:47], 0 offen offset:3072
    buffer_load_dwordx4 v[28:31], v249, s[44:47], 0 offen offset:3072
    v_add_u32 v248, 4096, v248
    v_add_u32 v249, 4096, v249
    buffer_load_dwordx4 v[32:35], v248, s[44:47], 0 offen offset:0
    buffer_load_dwordx4 v[36:39], v249, s[44:47], 0 offen offset:0
    buffer_load_dwordx4 v[40:43], v248, s[44:47], 0 offen offset:1024
    buffer_load_dwordx4 v[44:47], v249, s[44:47], 0 offen offset:1024
    buffer_load_dwordx4 v[48:51], v248, s[44:47], 0 offen offset:2048
    buffer_load_dwordx4 v[52:55], v249, s[44:47], 0 offen offset:2048
    buffer_load_dwordx4 v[56:59], v248, s[44:47], 0 offen offset:3072
    buffer_load_dwordx4 v[60:63], v249, s[44:47], 0 offen offset:3072
    s_lshl_b32 s91, s10, 7
    s_add_u32 s91, s91, 16850944
    s_lshl_b32 s92, s10, 7
    s_add_u32 s92, s92, 16855040
    s_mov_b32 s84, -1
    s_mov_b32 s85, 0
    v_lshlrev_b32 v250, 2, v254
    s_cmp_lg_u32 s3, 0
    s_cbranch_scc1 .Lfc_wait
    s_mov_b32 exec_hi, 0
    s_mov_b32 s74, 16384
.Lfc_poll:
    buffer_load_dword v251, v250, s[44:47], s92 offen sc1
    buffer_load_dword v252, v250, s[44:47], s91 offen sc1
    s_waitcnt vmcnt(0)
    v_cmp_ne_u32 vcc, s13, v251
    s_and_b64 s[72:73], vcc, s[84:85]
    v_cmp_ne_u32 vcc, s13, v252
    s_and_b32 s73, vcc_lo, 0x20002000
    s_or_b32 s72, s72, s73
    s_cbranch_scc0 .Lfc_ok
    s_sleep 2
    s_sub_u32 s74, s74, 1
    s_cmp_lg_u32 s74, 0
    s_cbranch_scc1 .Lfc_poll
.Lfc_ok:
    s_mov_b64 exec, -1
    v_mov_b32 v251, 155664
    v_mov_b32 v252, 1
    ds_write_b32 v251, v252
    s_branch .Lfc_go
.Lfc_wait:
    v_mov_b32 v251, 155664
    s_mov_b32 s74, 262144
.Lfc_lw:
    ds_read_b32 v252, v251
    s_waitcnt lgkmcnt(0)
    v_readfirstlane_b32 s72, v252
    s_cmp_lg_u32 s72, 0
    s_cbranch_scc1 .Lfc_lok
    s_sleep 1
    s_sub_u32 s74, s74, 1
    s_cmp_lg_u32 s74, 0
    s_cbranch_scc1 .Lfc_lw
.Lfc_lok:
.Lfc_go:
    s_lshl_b32 s72, s3, 13
    s_add_u32 s72, s72, 88064
    v_add_u32 v248, s72, v247
    buffer_load_dwordx4 v[64:67], v248, s[76:79], 0 offen offset:0
    buffer_load_dwordx4 v[68:71], v248, s[80:83], 0 offen offset:0
    buffer_load_dwordx4 v[72:75], v248, s[76:79], 0 offen offset:1024
    buffer_load_dwordx4 v[76:79], v248, s[80:83], 0 offen offset:1024
    buffer_load_dwordx4 v[80:83], v248, s[76:79], 0 offen offset:2048
    buffer_load_dwordx4 v[84:87], v248, s[80:83], 0 offen offset:2048
    buffer_load_dwordx4 v[88:91], v248, s[76:79], 0 offen offset:3072
    buffer_load_dwordx4 v[92:95], v248, s[80:83], 0 offen offset:3072
    v_add_u32 v248, 4096, v248
    buffer_load_dwordx4 v[96:99], v248, s[76:79], 0 offen offset:0
    buffer_load_dwordx4 v[100:103], v248, s[80:83], 0 offen offset:0
    buffer_load_dwordx4 v[104:107], v248, s[76:79], 0 offen offset:1024
    buffer_load_dwordx4 v[108:111], v248, s[80:83], 0 offen offset:1024
    buffer_load_dwordx4 v[112:115], v248, s[76:79], 0 offen offset:2048
    buffer_load_dwordx4 v[116:119], v248, s[80:83], 0 offen offset:2048
    buffer_load_dwordx4 v[120:123], v248, s[76:79], 0 offen offset:3072
    buffer_load_dwordx4 v[124:127], v248, s[80:83], 0 offen offset:3072
    v_and_b32 v250, 31, v254
    v_lshlrev_b32 v250, 2, v250
    s_lshl_b32 s72, s10, 8
    s_add_u32 s72, s72, 16777216
    buffer_load_dword v240, v250, s[44:47], s72 offen
    buffer_load_dword v241, v250, s[44:47], s72 offen offset:128
    s_waitcnt vmcnt(16)
    v_mfma_f32_32x32x16_bf16 v[160:175], v[0:3], v[64:67], 0
    v_mfma_f32_32x32x16_bf16 v[176:191], v[0:3], v[68:71], 0
    v_mfma_f32_32x32x16_bf16 v[192:207], v[4:7], v[64:67], 0
    v_mfma_f32_32x32x16_bf16 v[208:223], v[4:7], v[68:71], 0
    s_waitcnt vmcnt(14)
    v_mfma_f32_32x32x16_bf16 v[160:175], v[8:11], v[72:75], v[160:175]
    v_mfma_f32_32x32x16_bf16 v[176:191], v[8:11], v[76:79], v[176:191]
    v_mfma_f32_32x32x16_bf16 v[192:207], v[12:15], v[72:75], v[192:207]
    v_mfma_f32_32x32x16_bf16 v[208:223], v[12:15], v[76:79], v[208:223]
    s_waitcnt vmcnt(12)
    v_mfma_f32_32x32x16_bf16 v[160:175], v[16:19], v[80:83], v[160:175]
    v_mfma_f32_32x32x16_bf16 v[176:191], v[16:19], v[84:87], v[176:191]
    v_mfma_f32_32x32x16_bf16 v[192:207], v[20:23], v[80:83], v[192:207]
    v_mfma_f32_32x32x16_bf16 v[208:223], v[20:23], v[84:87], v[208:223]
    s_waitcnt vmcnt(10)
    v_mfma_f32_32x32x16_bf16 v[160:175], v[24:27], v[88:91], v[160:175]
    v_mfma_f32_32x32x16_bf16 v[176:191], v[24:27], v[92:95], v[176:191]
    v_mfma_f32_32x32x16_bf16 v[192:207], v[28:31], v[88:91], v[192:207]
    v_mfma_f32_32x32x16_bf16 v[208:223], v[28:31], v[92:95], v[208:223]
    s_waitcnt vmcnt(8)
    v_mfma_f32_32x32x16_bf16 v[160:175], v[32:35], v[96:99], v[160:175]
    v_mfma_f32_32x32x16_bf16 v[176:191], v[32:35], v[100:103], v[176:191]
    v_mfma_f32_32x32x16_bf16 v[192:207], v[36:39], v[96:99], v[192:207]
    v_mfma_f32_32x32x16_bf16 v[208:223], v[36:39], v[100:103], v[208:223]
    s_waitcnt vmcnt(6)
    v_mfma_f32_32x32x16_bf16 v[160:175], v[40:43], v[104:107], v[160:175]
    v_mfma_f32_32x32x16_bf16 v[176:191], v[40:43], v[108:111], v[176:191]
    v_mfma_f32_32x32x16_bf16 v[192:207], v[44:47], v[104:107], v[192:207]
    v_mfma_f32_32x32x16_bf16 v[208:223], v[44:47], v[108:111], v[208:223]
    s_waitcnt vmcnt(4)
    v_mfma_f32_32x32x16_bf16 v[160:175], v[48:51], v[112:115], v[160:175]
    v_mfma_f32_32x32x16_bf16 v[176:191], v[48:51], v[116:119], v[176:191]
    v_mfma_f32_32x32x16_bf16 v[192:207], v[52:55], v[112:115], v[192:207]
    v_mfma_f32_32x32x16_bf16 v[208:223], v[52:55], v[116:119], v[208:223]
    s_waitcnt vmcnt(2)
    v_mfma_f32_32x32x16_bf16 v[160:175], v[56:59], v[120:123], v[160:175]
    v_mfma_f32_32x32x16_bf16 v[176:191], v[56:59], v[124:127], v[176:191]
    v_mfma_f32_32x32x16_bf16 v[192:207], v[60:63], v[120:123], v[192:207]
    v_mfma_f32_32x32x16_bf16 v[208:223], v[60:63], v[124:127], v[208:223]
    s_waitcnt vmcnt(0)
    s_lshl_b32 s90, s3, 14
    s_add_u32 s90, s90, 32768
    v_mov_b32 v248, 155652
    s_mov_b32 s74, 16384
.Lcnt_poll:
    ds_read_b32 v249, v248
    s_waitcnt lgkmcnt(0)
    v_readfirstlane_b32 s72, v249
    s_cmp_eq_u32 s72, 4
    s_cbranch_scc1 .Lreduce
    s_sub_u32 s74, s74, 1
    s_cmp_lg_u32 s74, 0
    s_cbranch_scc1 .Lcnt_poll
.Lreduce:
    v_and_b32 v1, 31, v254
    v_lshrrev_b32 v3, 5, v254
    v_and_b32 v6, 15, v254
    v_lshlrev_b32 v1, 8, v1
    v_add_u32 v1, s90, v1
    v_xor_b32 v3, v3, v6
    s_nop 4
    v_mul_f32 v160, v160, v240
    v_mul_f32 v161, v161, v240
    v_mul_f32 v162, v162, v240
    v_mul_f32 v163, v163, v240
    v_mul_f32 v164, v164, v240
    v_mul_f32 v165, v165, v240
    v_mul_f32 v166, v166, v240
    v_mul_f32 v167, v167, v240
    v_mul_f32 v168, v168, v240
    v_mul_f32 v169, v169, v240
    v_mul_f32 v170, v170, v240
    v_mul_f32 v171, v171, v240
    v_mul_f32 v172, v172, v240
    v_mul_f32 v173, v173, v240
    v_mul_f32 v174, v174, v240
    v_mul_f32 v175, v175, v240
    v_mul_f32 v176, v176, v241
    v_mul_f32 v177, v177, v241
    v_mul_f32 v178, v178, v241
    v_mul_f32 v179, v179, v241
    v_mul_f32 v180, v180, v241
    v_mul_f32 v181, v181, v241
    v_mul_f32 v182, v182, v241
    v_mul_f32 v183, v183, v241
    v_mul_f32 v184, v184, v241
    v_mul_f32 v185, v185, v241
    v_mul_f32 v186, v186, v241
    v_mul_f32 v187, v187, v241
    v_mul_f32 v188, v188, v241
    v_mul_f32 v189, v189, v241
    v_mul_f32 v190, v190, v241
    v_mul_f32 v191, v191, v241
    v_mul_f32 v192, v192, v240
    v_mul_f32 v193, v193, v240
    v_mul_f32 v194, v194, v240
    v_mul_f32 v195, v195, v240
    v_mul_f32 v196, v196, v240
    v_mul_f32 v197, v197, v240
    v_mul_f32 v198, v198, v240
    v_mul_f32 v199, v199, v240
    v_mul_f32 v200, v200, v240
    v_mul_f32 v201, v201, v240
    v_mul_f32 v202, v202, v240
    v_mul_f32 v203, v203, v240
    v_mul_f32 v204, v204, v240
    v_mul_f32 v205, v205, v240
    v_mul_f32 v206, v206, v240
    v_mul_f32 v207, v207, v240
    v_mul_f32 v208, v208, v241
    v_mul_f32 v209, v209, v241
    v_mul_f32 v210, v210, v241
    v_mul_f32 v211, v211, v241
    v_mul_f32 v212, v212, v241
    v_mul_f32 v213, v213, v241
    v_mul_f32 v214, v214, v241
    v_mul_f32 v215, v215, v241
    v_mul_f32 v216, v216, v241
    v_mul_f32 v217, v217, v241
    v_mul_f32 v218, v218, v241
    v_mul_f32 v219, v219, v241
    v_mul_f32 v220, v220, v241
    v_mul_f32 v221, v221, v241
    v_mul_f32 v222, v222, v241
    v_mul_f32 v223, v223, v241
    v_xor_b32 v7, 0, v3
    v_lshl_add_u32 v8, v7, 4, v1
    v_xor_b32 v7, 2, v3
    v_lshl_add_u32 v9, v7, 4, v1
    v_xor_b32 v7, 4, v3
    v_lshl_add_u32 v10, v7, 4, v1
    v_xor_b32 v7, 6, v3
    v_lshl_add_u32 v11, v7, 4, v1
    v_xor_b32 v7, 8, v3
    v_lshl_add_u32 v12, v7, 4, v1
    v_xor_b32 v7, 10, v3
    v_lshl_add_u32 v13, v7, 4, v1
    v_xor_b32 v7, 12, v3
    v_lshl_add_u32 v14, v7, 4, v1
    v_xor_b32 v7, 14, v3
    v_lshl_add_u32 v15, v7, 4, v1
    ds_write_b128 v8, v[160:163] offset:0
    ds_write_b128 v9, v[164:167] offset:0
    ds_write_b128 v10, v[168:171] offset:0
    ds_write_b128 v11, v[172:175] offset:0
    ds_write_b128 v8, v[176:179] offset:8192
    ds_write_b128 v9, v[180:183] offset:8192
    ds_write_b128 v10, v[184:187] offset:8192
    ds_write_b128 v11, v[188:191] offset:8192
    ds_write_b128 v12, v[192:195] offset:0
    ds_write_b128 v13, v[196:199] offset:0
    ds_write_b128 v14, v[200:203] offset:0
    ds_write_b128 v15, v[204:207] offset:0
    ds_write_b128 v12, v[208:211] offset:8192
    ds_write_b128 v13, v[212:215] offset:8192
    ds_write_b128 v14, v[216:219] offset:8192
    ds_write_b128 v15, v[220:223] offset:8192
    s_waitcnt lgkmcnt(0)
    s_barrier
    v_lshrrev_b32 v1, 3, v254
    s_lshl_b32 s72, s3, 3
    v_add_u32 v1, s72, v1
    v_and_b32 v3, 7, v254
    v_and_b32 v6, 15, v1
    v_lshlrev_b32 v7, 1, v3
    v_xor_b32 v7, v7, v6
    v_xor_b32 v6, 1, v7
    v_lshlrev_b32 v4, 8, v1
    v_lshl_add_u32 v7, v7, 4, v4
    v_lshl_add_u32 v6, v6, 4, v4
    v_add_u32 v4, 32768, v7
    v_add_u32 v5, 32768, v6
    v_add_u32 v2, 98304, v7
    v_add_u32 v0, 98304, v6
    ds_read_b128 v[8:11], v4 offset:0
    ds_read_b128 v[12:15], v5 offset:0
    ds_read_b128 v[16:19], v4 offset:16384
    ds_read_b128 v[20:23], v5 offset:16384
    ds_read_b128 v[24:27], v4 offset:32768
    ds_read_b128 v[28:31], v5 offset:32768
    ds_read_b128 v[32:35], v4 offset:49152
    ds_read_b128 v[36:39], v5 offset:49152
    ds_read_b128 v[40:43], v7 offset:0
    ds_read_b128 v[44:47], v6 offset:0
    ds_read_b128 v[48:51], v7 offset:16384
    ds_read_b128 v[52:55], v6 offset:16384
    ds_read_b128 v[56:59], v2 offset:0
    ds_read_b128 v[60:63], v0 offset:0
    ds_read_b128 v[64:67], v2 offset:16384
    ds_read_b128 v[68:71], v0 offset:16384
    s_waitcnt lgkmcnt(0)
    v_add_f32 v8, v8, v40
    v_add_f32 v9, v9, v41
    v_add_f32 v10, v10, v42
    v_add_f32 v11, v11, v43
    v_add_f32 v12, v12, v44
    v_add_f32 v13, v13, v45
    v_add_f32 v14, v14, v46
    v_add_f32 v15, v15, v47
    v_add_f32 v16, v16, v48
    v_add_f32 v17, v17, v49
    v_add_f32 v18, v18, v50
    v_add_f32 v19, v19, v51
    v_add_f32 v20, v20, v52
    v_add_f32 v21, v21, v53
    v_add_f32 v22, v22, v54
    v_add_f32 v23, v23, v55
    v_add_f32 v24, v24, v56
    v_add_f32 v25, v25, v57
    v_add_f32 v26, v26, v58
    v_add_f32 v27, v27, v59
    v_add_f32 v28, v28, v60
    v_add_f32 v29, v29, v61
    v_add_f32 v30, v30, v62
    v_add_f32 v31, v31, v63
    v_add_f32 v32, v32, v64
    v_add_f32 v33, v33, v65
    v_add_f32 v34, v34, v66
    v_add_f32 v35, v35, v67
    v_add_f32 v36, v36, v68
    v_add_f32 v37, v37, v69
    v_add_f32 v38, v38, v70
    v_add_f32 v39, v39, v71
    v_add_f32 v8, v8, v24
    v_add_f32 v9, v9, v25
    v_add_f32 v10, v10, v26
    v_add_f32 v11, v11, v27
    v_add_f32 v12, v12, v28
    v_add_f32 v13, v13, v29
    v_add_f32 v14, v14, v30
    v_add_f32 v15, v15, v31
    v_add_f32 v16, v16, v32
    v_add_f32 v17, v17, v33
    v_add_f32 v18, v18, v34
    v_add_f32 v19, v19, v35
    v_add_f32 v20, v20, v36
    v_add_f32 v21, v21, v37
    v_add_f32 v22, v22, v38
    v_add_f32 v23, v23, v39
    v_add_f32 v8, v8, v16
    v_add_f32 v9, v9, v17
    v_add_f32 v10, v10, v18
    v_add_f32 v11, v11, v19
    v_add_f32 v12, v12, v20
    v_add_f32 v13, v13, v21
    v_add_f32 v14, v14, v22
    v_add_f32 v15, v15, v23
    v_cvt_pk_bf16_f32 v8, v8, v9
    v_cvt_pk_bf16_f32 v9, v10, v11
    v_cvt_pk_bf16_f32 v10, v12, v13
    v_cvt_pk_bf16_f32 v11, v14, v15
    s_lshl_b32 s72, s10, 16
    s_lshl_b32 s73, s11, 7
    s_add_u32 s72, s72, s73
    v_lshlrev_b32 v1, 10, v1
    v_lshl_add_u32 v1, v3, 4, v1
    buffer_store_dwordx4 v[8:11], v1, s[60:63], s72 offen
.Lend:
    s_endpgm
.section .rodata,"a"
.p2align 6
.amdhsa_kernel gated_mix__sliding_block__dense_activation_relu__prompt_kernel
  .amdhsa_next_free_vgpr 256
  .amdhsa_next_free_sgpr 100
  .amdhsa_accum_offset 256
  .amdhsa_group_segment_fixed_size 0
  .amdhsa_kernarg_size 80
  .amdhsa_user_sgpr_count 2
  .amdhsa_user_sgpr_kernarg_segment_ptr 1
  .amdhsa_system_sgpr_workgroup_id_x 1
.end_amdhsa_kernel
```
